```python
import torch

def _softmax(x, axis=-1):
    return torch.softmax(x, dim=axis)
def _gelu(x):
    return torch.nn.functional.gelu(x, approximate="tanh")
def _silu(x):
    return torch.nn.functional.silu(x)
def _sigmoid(x):
    return torch.sigmoid(x)
def _layernorm(x, axis=-1, eps=1e-5):
    m = x.mean(dim=axis, keepdim=True)
    v = x.var(dim=axis, keepdim=True, unbiased=False)
    return (x - m) / torch.sqrt(v + eps)
def _scatter_add(tgt, idx, src, axis=0):
    return tgt.clone().index_add_(axis, idx, src)
def _segment_sum(src, seg, n):
    out = torch.zeros((n,) + src.shape[1:], dtype=src.dtype)
    return out.index_add_(0, seg, src)
def _pad(x, pw):
    flat = tuple(v for pair in reversed(pw) for v in pair)
    return torch.nn.functional.pad(x, flat)

kernel_name = 'concat_heads__linear_attn_block__grouped_kv_mqa__prompt'

def setup_inputs():

    _w = (lambda a: (lambda t: t.to(torch.bfloat16) if t.is_floating_point() else t)(torch.as_tensor(a)))
    def _A_setup():
        B, S, D = 1, 2048, 1024
        return {
            "x": _w((lambda *s: torch.randn(*s, dtype=torch.bfloat16) * 0.05)(B, S, D)),
            "wqkv": _w((lambda *s: torch.randn(*s, dtype=torch.bfloat16) * 0.8)(D, 3 * D)),
            "wo": _w((lambda *s: torch.randn(*s, dtype=torch.bfloat16) * 0.05)(D, D)),
        }
    _A_in = _A_setup()

    def _B_setup():
        B, S, D, H = 1, 2048, 1024, 32
        Dh = D // H
        return {
            "x": _w((lambda *s: torch.randn(*s, dtype=torch.bfloat16) * 0.05)(B, S, D)),
            "wq": _w((lambda *s: torch.randn(*s, dtype=torch.bfloat16) * 0.8)(D, H * Dh)),
            "wk": _w((lambda *s: torch.randn(*s, dtype=torch.bfloat16) * 0.8)(D, Dh)),
            "wv": _w((lambda *s: torch.randn(*s, dtype=torch.bfloat16) * 0.05)(D, Dh)),
            "wo": _w((lambda *s: torch.randn(*s, dtype=torch.bfloat16) * 0.05)(H * Dh, D)),
        }
    _B_in = _B_setup()

    return {
        "A_x": _A_in["x"],
        "A_wqkv": _A_in["wqkv"],
        "A_wo": _A_in["wo"],
        "B_x": _B_in["x"],
        "B_wq": _B_in["wq"],
        "B_wk": _B_in["wk"],
        "B_wv": _B_in["wv"],
        "B_wo": _B_in["wo"],
    }

def reference(A_x, A_wqkv, A_wo, B_x, B_wq, B_wk, B_wv, B_wo):
    def _A_ref(x, wqkv, wo):
        B, S, D = x.shape
        H = 32; Dh = D // H
        qkv = (lambda x, *d: x.permute(*d))((x @ wqkv).reshape(B, S, 3, H, Dh), 2, 0, 3, 1, 4)
        q, k, v = qkv[0], qkv[1], qkv[2]
        phi = lambda t: torch.where(t > 0, t + 1, torch.exp(t)) + 1e-6
        pq, pk = phi(q), phi(k)
        kv = torch.einsum("bhsd,bhse->bhde", pk, v)
        z = torch.einsum("bhsd->bhd", pk)
        num = torch.einsum("bhqd,bhde->bhqe", pq, kv)
        den = torch.einsum("bhqd,bhd->bhq", pq, z)[..., None] + 1e-6
        o = num / den
        return (lambda x, *d: x.permute(*d))(o, 0, 2, 1, 3).reshape(B, S, D) @ wo

    def _B_ref(x, wq, wk, wv, wo):
        B, S, D = x.shape
        H = 32
        Dh = D // H
        q = (lambda x, *d: x.permute(*d))((x @ wq).reshape(B, S, H, Dh), 0, 2, 1, 3)
        k = x @ wk
        v = x @ wv
        scores = torch.einsum("bhqd,bkd->bhqk", q, k) * (Dh ** -0.5)
        p = _softmax(scores, axis=-1)
        o = torch.einsum("bhqk,bkd->bhqd", p, v)
        return (lambda x, *d: x.permute(*d))(o, 0, 2, 1, 3).reshape(B, S, H * Dh) @ wo

    a = _A_ref(A_x, A_wqkv, A_wo)
    b = _B_ref(B_x, B_wq, B_wk, B_wv, B_wo)
    return torch.concatenate([a, b], axis=-1)
```

```asm
; @launch grid=(256,1,1) block=(768,1,1) lds=163840
.amdgcn_target "amdgcn-amd-amdhsa--gfx950"
.text
.globl concat_heads__linear_attn_block__grouped_kv_mqa__prompt_kernel
.p2align 8
.type concat_heads__linear_attn_block__grouped_kv_mqa__prompt_kernel,@function
concat_heads__linear_attn_block__grouped_kv_mqa__prompt_kernel:
    s_cmp_ge_u32 s2, 256
    s_cbranch_scc1 L_end
    s_load_dwordx16 s[44:59], s[0:1], 0
    s_load_dwordx4 s[60:63], s[0:1], 64
    s_load_dwordx2 s[64:65], s[0:1], 80
    v_lshrrev_b32 v1, 6, v0
    v_and_b32 v0, 63, v0
    s_and_b32 s70, s2, 7
    s_lshr_b32 s71, s2, 3
    v_readfirstlane_b32 s66, v1
    s_lshr_b32 s67, s70, 1
    s_lshl_b32 s67, s67, 2
    s_and_b32 s72, s71, 3
    s_add_u32 s67, s67, s72
    s_and_b32 s68, s70, 1
    s_xor_b32 s68, s68, 0
    s_lshl_b32 s68, s68, 3
    s_lshr_b32 s72, s71, 2
    s_add_u32 s68, s68, s72
    v_lshlrev_b32 v3, 4, v0
    s_and_b32 s69, s66, 3
    s_cmp_ge_u32 s66, 8
    s_cbranch_scc1 L_gm
    s_cmp_lt_u32 s66, 4
    s_cbranch_scc1 L_kl
    v_lshrrev_b32 v60, 3, v0
    v_lshrrev_b32 v61, 4, v0
    v_and_b32 v62, 7, v0
    s_lshl_b32 s70, s67, 7
    s_lshl_b32 s71, s69, 5
    s_add_u32 s70, s70, s71
    s_lshl_b32 s70, s70, 11
    v_lshlrev_b32 v60, 11, v60
    v_add_u32 v60, s70, v60
    v_add_u32 v63, 0, v61
    v_and_b32 v63, 7, v63
    v_xor_b32 v63, v63, v62
    v_lshl_add_u32 v128, v63, 4, v60
    v_add_u32 v63, 4, v61
    v_and_b32 v63, 7, v63
    v_xor_b32 v63, v63, v62
    v_lshl_add_u32 v129, v63, 4, v60
    v_add_u32 v129, 15360, v129
    v_add_u32 v63, 8, v61
    v_and_b32 v63, 7, v63
    v_xor_b32 v63, v63, v62
    v_lshl_add_u32 v130, v63, 4, v60
    v_add_u32 v130, 30720, v130
    v_add_u32 v63, 12, v61
    v_and_b32 v63, 7, v63
    v_xor_b32 v63, v63, v62
    v_lshl_add_u32 v131, v63, 4, v60
    v_add_u32 v131, 46080, v131
    v_lshrrev_b32 v60, 3, v0
    s_lshl_b32 s70, s69, 4
    v_add_u32 v60, s70, v60
    s_movk_i32 s70, 2048
    v_mul_lo_u32 v60, v60, s70
    v_bfe_u32 v61, v0, 4, 1
    v_lshlrev_b32 v61, 2, v61
    v_and_b32 v132, 7, v0
    v_xor_b32 v61, v61, v132
    v_lshl_add_u32 v132, v61, 4, v60
    s_lshl_b32 s70, s68, 7
    v_add_u32 v132, s70, v132
    v_add_u32 v133, 15360, v132
    s_lshl_b32 s70, s69, 10
    v_add_u32 v136, s70, v3
    v_xor_b32 v133, 32, v133
    v_and_b32 v60, 32, v0
    v_xor_b32 v136, v136, v60
    s_lshl_b32 s73, s69, 12
    s_lshl_b32 s74, s69, 11
    s_add_u32 s74, s74, 16384
    s_lshl_b32 s75, s69, 10
    s_add_u32 s75, s75, 24576
    s_mov_b32 s76, 0
    s_mov_b32 s77, 102400
    s_mul_i32 s83, s67, 0
    s_mul_i32 s82, s68, 0
    s_add_u32 s83, s83, s82
    s_lshr_b32 s82, s67, 2
    s_mul_i32 s82, s82, 4
    s_add_u32 s83, s83, s82
    s_lshr_b32 s82, s68, 3
    s_mul_i32 s82, s82, 8
    s_add_u32 s83, s83, s82
    s_mov_b32 s22, 0x10000
    s_mov_b32 s23, 0x00020000
    s_waitcnt lgkmcnt(0)
    s_mov_b32 s4, s50
    s_mov_b32 s5, s51
    s_mov_b32 s6, 0x400000
    s_mov_b32 s7, 0x00020000
    s_mov_b32 s12, s52
    s_mov_b32 s13, s53
    s_mov_b32 s14, 0x200000
    s_mov_b32 s15, 0x00020000
    s_bitcmp1_b32 s68, 2
    s_cselect_b32 s20, s56, s54
    s_cselect_b32 s21, s57, s55
    s_mov_b32 s8, s44
    s_mov_b32 s9, s45
    s_mov_b32 s10, 0x400000
    s_mov_b32 s11, 0x00020000
    s_mov_b32 s16, s46
    s_mov_b32 s17, s47
    s_mov_b32 s18, 0x600000
    s_mov_b32 s19, 0x00020000
    s_and_b32 s80, s68, 1
    s_mul_i32 s80, s80, 0
    s_and_b32 s81, s67, 1
    s_mul_i32 s81, s81, 0
    s_add_u32 s80, s80, s81
    s_add_u32 s83, s83, s80
    s_cmp_ge_u32 s68, 8
    s_cbranch_scc1 L_ldn
    s_add_u32 s82, s76, s83
    s_and_b32 s82, s82, 15
    s_lshl_b32 s78, s82, 7
    s_add_u32 m0, s73, 102400
    s_lshl_b32 s79, s82, 17
    buffer_load_dwordx4 v128, s[4:7], s78 offen offset:0  lds
    buffer_load_dwordx4 v129, s[4:7], s78 offen offset:1024  lds
    buffer_load_dwordx4 v130, s[4:7], s78 offen offset:2048  lds
    buffer_load_dwordx4 v131, s[4:7], s78 offen offset:3072  lds
    s_add_u32 m0, s74, 102400
    s_lshl_b32 s78, s82, 12
    buffer_load_dwordx4 v132, s[12:15], s79 offen offset:0  lds
    buffer_load_dwordx4 v133, s[12:15], s79 offen offset:1024  lds
    s_add_u32 m0, s75, 102400
    s_add_u32 s76, s76, 1
    buffer_load_dwordx4 v136, s[20:23], s78 offen lds
    s_add_u32 s82, s76, s83
    s_and_b32 s82, s82, 15
    s_lshl_b32 s78, s82, 7
    s_add_u32 m0, s73, 0
    s_lshl_b32 s79, s82, 17
    buffer_load_dwordx4 v128, s[4:7], s78 offen offset:0  lds
    buffer_load_dwordx4 v129, s[4:7], s78 offen offset:1024  lds
    buffer_load_dwordx4 v130, s[4:7], s78 offen offset:2048  lds
    buffer_load_dwordx4 v131, s[4:7], s78 offen offset:3072  lds
    s_add_u32 m0, s74, 126976
    s_lshl_b32 s78, s82, 12
    buffer_load_dwordx4 v132, s[12:15], s79 offen offset:0  lds
    buffer_load_dwordx4 v133, s[12:15], s79 offen offset:1024  lds
    s_add_u32 m0, s75, 126976
    s_add_u32 s76, s76, 1
    buffer_load_dwordx4 v136, s[20:23], s78 offen lds
    s_barrier
    s_mov_b32 s32, s64
    s_mov_b32 s33, s65
    s_mov_b32 s34, 0x900000
    s_mov_b32 s35, 0x00020000
    s_mov_b32 s28, s58
    s_mov_b32 s29, s59
    s_mov_b32 s30, 0x200000
    s_mov_b32 s31, 0x00020000
    v_lshrrev_b32 v60, 3, v0
    s_lshl_b32 s70, s69, 4
    v_add_u32 v60, s70, v60
    s_movk_i32 s70, 6144
    v_mul_lo_u32 v60, v60, s70
    v_bfe_u32 v61, v0, 4, 1
    v_lshlrev_b32 v61, 2, v61
    v_and_b32 v134, 7, v0
    v_xor_b32 v61, v61, v134
    v_lshl_add_u32 v134, v61, 4, v60
    s_lshl_b32 s70, s68, 7
    v_add_u32 v134, s70, v134
    v_add_u32 v135, 48128, v134
    v_xor_b32 v135, 32, v134
    v_add_u32 v135, 48128, v135
    s_waitcnt vmcnt(7)
    s_barrier
    s_add_u32 s82, s76, s83
    s_and_b32 s82, s82, 15
    s_lshl_b32 s78, s82, 7
    s_add_u32 m0, s73, 20480
    s_lshl_b32 s79, s82, 17
    buffer_load_dwordx4 v128, s[4:7], s78 offen offset:0  lds
    buffer_load_dwordx4 v129, s[4:7], s78 offen offset:1024  lds
    buffer_load_dwordx4 v130, s[4:7], s78 offen offset:2048  lds
    buffer_load_dwordx4 v131, s[4:7], s78 offen offset:3072  lds
    s_add_u32 m0, s74, 20480
    s_lshl_b32 s78, s82, 12
    buffer_load_dwordx4 v132, s[12:15], s79 offen offset:0  lds
    buffer_load_dwordx4 v133, s[12:15], s79 offen offset:1024  lds
    s_add_u32 m0, s75, 20480
    s_add_u32 s76, s76, 1
    buffer_load_dwordx4 v136, s[20:23], s78 offen lds
    s_add_u32 s82, s76, s83
    s_and_b32 s82, s82, 15
    s_lshl_b32 s78, s82, 7
    s_add_u32 m0, s73, 61440
    s_lshl_b32 s79, s82, 17
    buffer_load_dwordx4 v128, s[4:7], s78 offen offset:0  lds
    buffer_load_dwordx4 v129, s[4:7], s78 offen offset:1024  lds
    buffer_load_dwordx4 v130, s[4:7], s78 offen offset:2048  lds
    buffer_load_dwordx4 v131, s[4:7], s78 offen offset:3072  lds
    s_add_u32 m0, s74, 61440
    s_lshl_b32 s78, s82, 12
    buffer_load_dwordx4 v132, s[12:15], s79 offen offset:0  lds
    buffer_load_dwordx4 v133, s[12:15], s79 offen offset:1024  lds
    s_add_u32 m0, s75, 61440
    s_add_u32 s76, s76, 1
    buffer_load_dwordx4 v136, s[20:23], s78 offen lds
L_ld17:
    s_waitcnt vmcnt(14)
    s_barrier
    s_add_u32 s82, s76, s83
    s_and_b32 s82, s82, 15
    s_lshl_b32 s78, s82, 7
    s_add_u32 m0, s73, 102400
    s_lshl_b32 s79, s82, 17
    buffer_load_dwordx4 v128, s[4:7], s78 offen offset:0  lds
    buffer_load_dwordx4 v129, s[4:7], s78 offen offset:1024  lds
    buffer_load_dwordx4 v130, s[4:7], s78 offen offset:2048  lds
    buffer_load_dwordx4 v131, s[4:7], s78 offen offset:3072  lds
    s_add_u32 m0, s74, 102400
    s_lshl_b32 s78, s82, 12
    buffer_load_dwordx4 v132, s[12:15], s79 offen offset:0  lds
    buffer_load_dwordx4 v133, s[12:15], s79 offen offset:1024  lds
    s_add_u32 m0, s75, 102400
    s_add_u32 s76, s76, 1
    buffer_load_dwordx4 v136, s[20:23], s78 offen lds
    s_waitcnt vmcnt(14)
    s_barrier
    s_add_u32 s82, s76, s83
    s_and_b32 s82, s82, 15
    s_lshl_b32 s78, s82, 7
    s_add_u32 m0, s73, 0
    s_lshl_b32 s79, s82, 17
    buffer_load_dwordx4 v128, s[4:7], s78 offen offset:0  lds
    buffer_load_dwordx4 v129, s[4:7], s78 offen offset:1024  lds
    buffer_load_dwordx4 v130, s[4:7], s78 offen offset:2048  lds
    buffer_load_dwordx4 v131, s[4:7], s78 offen offset:3072  lds
    s_add_u32 m0, s74, 126976
    s_lshl_b32 s78, s82, 12
    buffer_load_dwordx4 v132, s[12:15], s79 offen offset:0  lds
    buffer_load_dwordx4 v133, s[12:15], s79 offen offset:1024  lds
    s_add_u32 m0, s75, 126976
    s_add_u32 s76, s76, 1
    buffer_load_dwordx4 v136, s[20:23], s78 offen lds
    s_waitcnt vmcnt(14)
    s_barrier
    s_add_u32 s82, s76, s83
    s_and_b32 s82, s82, 15
    s_lshl_b32 s78, s82, 7
    s_add_u32 m0, s73, 20480
    s_lshl_b32 s79, s82, 17
    buffer_load_dwordx4 v128, s[4:7], s78 offen offset:0  lds
    buffer_load_dwordx4 v129, s[4:7], s78 offen offset:1024  lds
    buffer_load_dwordx4 v130, s[4:7], s78 offen offset:2048  lds
    buffer_load_dwordx4 v131, s[4:7], s78 offen offset:3072  lds
    s_add_u32 m0, s74, 20480
    s_lshl_b32 s78, s82, 12
    buffer_load_dwordx4 v132, s[12:15], s79 offen offset:0  lds
    buffer_load_dwordx4 v133, s[12:15], s79 offen offset:1024  lds
    s_add_u32 m0, s75, 20480
    s_add_u32 s76, s76, 1
    buffer_load_dwordx4 v136, s[20:23], s78 offen lds
    s_waitcnt vmcnt(14)
    s_barrier
    s_add_u32 s82, s76, s83
    s_and_b32 s82, s82, 15
    s_lshl_b32 s78, s82, 7
    s_add_u32 m0, s73, 61440
    s_lshl_b32 s79, s82, 17
    buffer_load_dwordx4 v128, s[4:7], s78 offen offset:0  lds
    buffer_load_dwordx4 v129, s[4:7], s78 offen offset:1024  lds
    buffer_load_dwordx4 v130, s[4:7], s78 offen offset:2048  lds
    buffer_load_dwordx4 v131, s[4:7], s78 offen offset:3072  lds
    s_add_u32 m0, s74, 61440
    s_lshl_b32 s78, s82, 12
    buffer_load_dwordx4 v132, s[12:15], s79 offen offset:0  lds
    buffer_load_dwordx4 v133, s[12:15], s79 offen offset:1024  lds
    s_add_u32 m0, s75, 61440
    s_add_u32 s76, s76, 1
    buffer_load_dwordx4 v136, s[20:23], s78 offen lds
    s_cmp_lt_u32 s76, 16
    s_cbranch_scc1 L_ld17
    s_mov_b32 s76, 0
    s_sub_u32 s83, s83, s80
    s_and_b32 s82, s68, 1
    s_mul_i32 s82, s82, 4
    s_add_u32 s83, s83, s82
    s_waitcnt vmcnt(14)
    s_barrier
    s_add_u32 s82, s76, s83
    s_and_b32 s82, s82, 15
    s_lshl_b32 s78, s82, 7
    s_add_u32 m0, s77, s73
    s_mul_i32 s79, s82, 393216
    buffer_load_dwordx4 v128, s[8:11], s78 offen offset:0  lds
    buffer_load_dwordx4 v129, s[8:11], s78 offen offset:1024  lds
    buffer_load_dwordx4 v130, s[8:11], s78 offen offset:2048  lds
    buffer_load_dwordx4 v131, s[8:11], s78 offen offset:3072  lds
    s_add_u32 s78, s77, s74
    s_add_u32 m0, s78, 0
    s_add_u32 s76, s76, 1
    buffer_load_dwordx4 v134, s[16:19], s79 offen offset:0  lds
    buffer_load_dwordx4 v135, s[16:19], s79 offen offset:1024  lds
    s_add_u32 m0, s78, 8192
    s_add_u32 s79, s79, 2048
    buffer_load_dwordx4 v134, s[16:19], s79 offen offset:0  lds
    buffer_load_dwordx4 v135, s[16:19], s79 offen offset:1024  lds
    s_add_u32 m0, s78, 16384
    s_add_u32 s79, s79, 2048
    buffer_load_dwordx4 v134, s[16:19], s79 offen offset:0  lds
    buffer_load_dwordx4 v135, s[16:19], s79 offen offset:1024  lds
    s_add_u32 s77, s77, 40960
    s_cmp_ge_u32 s77, 143360
    s_cselect_b32 s77, 20480, s77
    s_waitcnt vmcnt(17)
    s_barrier
    s_branch L_ld2
L_ldn:
    s_add_u32 s82, s76, s83
    s_and_b32 s82, s82, 15
    s_lshl_b32 s78, s82, 7
    s_add_u32 m0, s73, 102400
    s_lshl_b32 s79, s82, 17
    buffer_load_dwordx4 v128, s[4:7], s78 offen offset:0  lds
    buffer_load_dwordx4 v129, s[4:7], s78 offen offset:1024  lds
    buffer_load_dwordx4 v130, s[4:7], s78 offen offset:2048  lds
    buffer_load_dwordx4 v131, s[4:7], s78 offen offset:3072  lds
    s_add_u32 m0, s74, 102400
    s_lshl_b32 s78, s82, 12
    buffer_load_dwordx4 v132, s[12:15], s79 offen offset:0  lds
    buffer_load_dwordx4 v133, s[12:15], s79 offen offset:1024  lds
    s_add_u32 m0, s75, 102400
    s_add_u32 s76, s76, 1
    s_add_u32 s82, s76, s83
    s_and_b32 s82, s82, 15
    s_lshl_b32 s78, s82, 7
    s_add_u32 m0, s73, 0
    s_lshl_b32 s79, s82, 17
    buffer_load_dwordx4 v128, s[4:7], s78 offen offset:0  lds
    buffer_load_dwordx4 v129, s[4:7], s78 offen offset:1024  lds
    buffer_load_dwordx4 v130, s[4:7], s78 offen offset:2048  lds
    buffer_load_dwordx4 v131, s[4:7], s78 offen offset:3072  lds
    s_add_u32 m0, s74, 126976
    s_lshl_b32 s78, s82, 12
    buffer_load_dwordx4 v132, s[12:15], s79 offen offset:0  lds
    buffer_load_dwordx4 v133, s[12:15], s79 offen offset:1024  lds
    s_add_u32 m0, s75, 126976
    s_add_u32 s76, s76, 1
    s_barrier
    s_mov_b32 s32, s64
    s_mov_b32 s33, s65
    s_mov_b32 s34, 0x900000
    s_mov_b32 s35, 0x00020000
    s_mov_b32 s28, s58
    s_mov_b32 s29, s59
    s_mov_b32 s30, 0x200000
    s_mov_b32 s31, 0x00020000
    v_lshrrev_b32 v60, 3, v0
    s_lshl_b32 s70, s69, 4
    v_add_u32 v60, s70, v60
    s_movk_i32 s70, 6144
    v_mul_lo_u32 v60, v60, s70
    v_bfe_u32 v61, v0, 4, 1
    v_lshlrev_b32 v61, 2, v61
    v_and_b32 v134, 7, v0
    v_xor_b32 v61, v61, v134
    v_lshl_add_u32 v134, v61, 4, v60
    s_lshl_b32 s70, s68, 7
    v_add_u32 v134, s70, v134
    v_add_u32 v135, 48128, v134
    v_xor_b32 v135, 32, v134
    v_add_u32 v135, 48128, v135
    s_waitcnt vmcnt(6)
    s_barrier
    s_add_u32 s82, s76, s83
    s_and_b32 s82, s82, 15
    s_lshl_b32 s78, s82, 7
    s_add_u32 m0, s73, 20480
    s_lshl_b32 s79, s82, 17
    buffer_load_dwordx4 v128, s[4:7], s78 offen offset:0  lds
    buffer_load_dwordx4 v129, s[4:7], s78 offen offset:1024  lds
    buffer_load_dwordx4 v130, s[4:7], s78 offen offset:2048  lds
    buffer_load_dwordx4 v131, s[4:7], s78 offen offset:3072  lds
    s_add_u32 m0, s74, 20480
    s_lshl_b32 s78, s82, 12
    buffer_load_dwordx4 v132, s[12:15], s79 offen offset:0  lds
    buffer_load_dwordx4 v133, s[12:15], s79 offen offset:1024  lds
    s_add_u32 m0, s75, 20480
    s_add_u32 s76, s76, 1
    s_add_u32 s82, s76, s83
    s_and_b32 s82, s82, 15
    s_lshl_b32 s78, s82, 7
    s_add_u32 m0, s73, 61440
    s_lshl_b32 s79, s82, 17
    buffer_load_dwordx4 v128, s[4:7], s78 offen offset:0  lds
    buffer_load_dwordx4 v129, s[4:7], s78 offen offset:1024  lds
    buffer_load_dwordx4 v130, s[4:7], s78 offen offset:2048  lds
    buffer_load_dwordx4 v131, s[4:7], s78 offen offset:3072  lds
    s_add_u32 m0, s74, 61440
    s_lshl_b32 s78, s82, 12
    buffer_load_dwordx4 v132, s[12:15], s79 offen offset:0  lds
    buffer_load_dwordx4 v133, s[12:15], s79 offen offset:1024  lds
    s_add_u32 m0, s75, 61440
    s_add_u32 s76, s76, 1
L_ld16:
    s_waitcnt vmcnt(12)
    s_barrier
    s_add_u32 s82, s76, s83
    s_and_b32 s82, s82, 15
    s_lshl_b32 s78, s82, 7
    s_add_u32 m0, s73, 102400
    s_lshl_b32 s79, s82, 17
    buffer_load_dwordx4 v128, s[4:7], s78 offen offset:0  lds
    buffer_load_dwordx4 v129, s[4:7], s78 offen offset:1024  lds
    buffer_load_dwordx4 v130, s[4:7], s78 offen offset:2048  lds
    buffer_load_dwordx4 v131, s[4:7], s78 offen offset:3072  lds
    s_add_u32 m0, s74, 102400
    s_lshl_b32 s78, s82, 12
    buffer_load_dwordx4 v132, s[12:15], s79 offen offset:0  lds
    buffer_load_dwordx4 v133, s[12:15], s79 offen offset:1024  lds
    s_add_u32 m0, s75, 102400
    s_add_u32 s76, s76, 1
    s_waitcnt vmcnt(12)
    s_barrier
    s_add_u32 s82, s76, s83
    s_and_b32 s82, s82, 15
    s_lshl_b32 s78, s82, 7
    s_add_u32 m0, s73, 0
    s_lshl_b32 s79, s82, 17
    buffer_load_dwordx4 v128, s[4:7], s78 offen offset:0  lds
    buffer_load_dwordx4 v129, s[4:7], s78 offen offset:1024  lds
    buffer_load_dwordx4 v130, s[4:7], s78 offen offset:2048  lds
    buffer_load_dwordx4 v131, s[4:7], s78 offen offset:3072  lds
    s_add_u32 m0, s74, 126976
    s_lshl_b32 s78, s82, 12
    buffer_load_dwordx4 v132, s[12:15], s79 offen offset:0  lds
    buffer_load_dwordx4 v133, s[12:15], s79 offen offset:1024  lds
    s_add_u32 m0, s75, 126976
    s_add_u32 s76, s76, 1
    s_waitcnt vmcnt(12)
    s_barrier
    s_add_u32 s82, s76, s83
    s_and_b32 s82, s82, 15
    s_lshl_b32 s78, s82, 7
    s_add_u32 m0, s73, 20480
    s_lshl_b32 s79, s82, 17
    buffer_load_dwordx4 v128, s[4:7], s78 offen offset:0  lds
    buffer_load_dwordx4 v129, s[4:7], s78 offen offset:1024  lds
    buffer_load_dwordx4 v130, s[4:7], s78 offen offset:2048  lds
    buffer_load_dwordx4 v131, s[4:7], s78 offen offset:3072  lds
    s_add_u32 m0, s74, 20480
    s_lshl_b32 s78, s82, 12
    buffer_load_dwordx4 v132, s[12:15], s79 offen offset:0  lds
    buffer_load_dwordx4 v133, s[12:15], s79 offen offset:1024  lds
    s_add_u32 m0, s75, 20480
    s_add_u32 s76, s76, 1
    s_waitcnt vmcnt(12)
    s_barrier
    s_add_u32 s82, s76, s83
    s_and_b32 s82, s82, 15
    s_lshl_b32 s78, s82, 7
    s_add_u32 m0, s73, 61440
    s_lshl_b32 s79, s82, 17
    buffer_load_dwordx4 v128, s[4:7], s78 offen offset:0  lds
    buffer_load_dwordx4 v129, s[4:7], s78 offen offset:1024  lds
    buffer_load_dwordx4 v130, s[4:7], s78 offen offset:2048  lds
    buffer_load_dwordx4 v131, s[4:7], s78 offen offset:3072  lds
    s_add_u32 m0, s74, 61440
    s_lshl_b32 s78, s82, 12
    buffer_load_dwordx4 v132, s[12:15], s79 offen offset:0  lds
    buffer_load_dwordx4 v133, s[12:15], s79 offen offset:1024  lds
    s_add_u32 m0, s75, 61440
    s_add_u32 s76, s76, 1
    s_cmp_lt_u32 s76, 16
    s_cbranch_scc1 L_ld16
    s_mov_b32 s76, 0
    s_sub_u32 s83, s83, s80
    s_and_b32 s82, s68, 1
    s_mul_i32 s82, s82, 4
    s_add_u32 s83, s83, s82
    s_waitcnt vmcnt(12)
    s_barrier
    s_add_u32 s82, s76, s83
    s_and_b32 s82, s82, 15
    s_lshl_b32 s78, s82, 7
    s_add_u32 m0, s77, s73
    s_mul_i32 s79, s82, 393216
    buffer_load_dwordx4 v128, s[8:11], s78 offen offset:0  lds
    buffer_load_dwordx4 v129, s[8:11], s78 offen offset:1024  lds
    buffer_load_dwordx4 v130, s[8:11], s78 offen offset:2048  lds
    buffer_load_dwordx4 v131, s[8:11], s78 offen offset:3072  lds
    s_add_u32 s78, s77, s74
    s_add_u32 m0, s78, 0
    s_add_u32 s76, s76, 1
    buffer_load_dwordx4 v134, s[16:19], s79 offen offset:0  lds
    buffer_load_dwordx4 v135, s[16:19], s79 offen offset:1024  lds
    s_add_u32 m0, s78, 8192
    s_add_u32 s79, s79, 2048
    buffer_load_dwordx4 v134, s[16:19], s79 offen offset:0  lds
    buffer_load_dwordx4 v135, s[16:19], s79 offen offset:1024  lds
    s_add_u32 m0, s78, 16384
    s_add_u32 s79, s79, 2048
    buffer_load_dwordx4 v134, s[16:19], s79 offen offset:0  lds
    buffer_load_dwordx4 v135, s[16:19], s79 offen offset:1024  lds
    s_add_u32 s77, s77, 40960
    s_cmp_ge_u32 s77, 143360
    s_cselect_b32 s77, 20480, s77
    s_waitcnt vmcnt(16)
    s_barrier
L_ld2:
    s_waitcnt vmcnt(10)
    s_barrier
    s_add_u32 s82, s76, s83
    s_and_b32 s82, s82, 15
    s_lshl_b32 s78, s82, 7
    s_add_u32 m0, s77, s73
    s_mul_i32 s79, s82, 393216
    buffer_load_dwordx4 v128, s[8:11], s78 offen offset:0  lds
    buffer_load_dwordx4 v129, s[8:11], s78 offen offset:1024  lds
    buffer_load_dwordx4 v130, s[8:11], s78 offen offset:2048  lds
    buffer_load_dwordx4 v131, s[8:11], s78 offen offset:3072  lds
    s_add_u32 s78, s77, s74
    s_add_u32 m0, s78, 0
    s_add_u32 s76, s76, 1
    buffer_load_dwordx4 v134, s[16:19], s79 offen offset:0  lds
    buffer_load_dwordx4 v135, s[16:19], s79 offen offset:1024  lds
    s_add_u32 m0, s78, 8192
    s_add_u32 s79, s79, 2048
    buffer_load_dwordx4 v134, s[16:19], s79 offen offset:0  lds
    buffer_load_dwordx4 v135, s[16:19], s79 offen offset:1024  lds
    s_add_u32 m0, s78, 16384
    s_add_u32 s79, s79, 2048
    buffer_load_dwordx4 v134, s[16:19], s79 offen offset:0  lds
    buffer_load_dwordx4 v135, s[16:19], s79 offen offset:1024  lds
    s_add_u32 s77, s77, 40960
    s_cmp_ge_u32 s77, 143360
    s_cselect_b32 s77, 20480, s77
    s_cmp_lg_u32 s76, 4
    s_cbranch_scc1 L_ld2q
    s_lshl_b32 s70, s66, 11
    s_add_u32 s70, s70, 143360
    v_add_u32 v125, s70, v3
    ds_read_b128 v[4:7], v125 offset:0
    ds_read_b128 v[8:11], v125 offset:1024
    s_waitcnt lgkmcnt(0)
    v_and_b32 v126, 4, v0
    v_cmp_eq_u32 vcc, 0, v126
    v_mov_b32 v127, 0x3f803f80
    v_mov_b32 v100, 0
    v_mov_b32 v101, 0
    v_mov_b32 v102, 0
    v_mov_b32 v103, 0
    v_mov_b32 v104, 0
    v_mov_b32 v105, 0
    v_mov_b32 v106, 0
    v_mov_b32 v107, 0
    v_mov_b32 v108, 0
    v_mov_b32 v109, 0
    v_mov_b32 v110, 0
    v_mov_b32 v111, 0
    v_mov_b32 v112, 0
    v_mov_b32 v113, 0
    v_mov_b32 v114, 0
    v_mov_b32 v115, 0
    v_cndmask_b32 v120, 0, v127, vcc
    v_mov_b32 v121, v120
    v_xor_b32 v122, v120, v127
    v_mov_b32 v123, v122
    v_and_b32 v126, 1, v0
    v_mul_u32_u24 v1, 0xaaaa, v126
    v_add_u32 v1, 0x4444, v1
    v_mov_b32 v116, 0
    v_mov_b32 v117, 0
    v_mov_b32 v118, 0
    v_mov_b32 v119, 0
    v_mov_b32 v60, 0
    v_mov_b32 v61, 0
    v_mov_b32 v62, 0
    v_mov_b32 v63, 0
    v_mov_b32 v64, 0
    v_mov_b32 v65, 0
    v_mov_b32 v66, 0
    v_mov_b32 v67, 0
    v_mov_b32 v96, 0
    v_mov_b32 v97, 0
    v_mov_b32 v98, 0
    v_mov_b32 v99, 0
    v_mov_b32 v124, v3
L_ld2q:
    s_cmp_lt_u32 s76, 16
    s_cbranch_scc1 L_ld2
    s_waitcnt vmcnt(10)
    s_barrier
    v_add_u32 v125, 143360, v3
    ds_read_b128 v[84:87], v125 offset:0
    ds_read_b128 v[88:91], v125 offset:1024
    ds_read_b128 v[68:71], v125 offset:16384
    ds_read_b128 v[72:75], v125 offset:17408
    ds_read_b128 v[76:79], v125 offset:18432
    ds_read_b128 v[80:83], v125 offset:19456
    s_waitcnt lgkmcnt(0)
    s_setprio 3
    v_mfma_f32_32x32x16_bf16 v[28:43], v[84:87], v[4:7], 0
    v_mfma_f32_32x32x16_bf16 v[28:43], v[88:91], v[8:11], v[28:43]
    s_setprio 0
    s_nop 15
    v_max3_f32 v126, v28, v29, v30
    v_max3_f32 v126, v126, v31, v32
    v_max3_f32 v126, v126, v33, v34
    v_max3_f32 v126, v126, v35, v36
    v_max3_f32 v126, v126, v37, v38
    v_max3_f32 v126, v126, v39, v40
    v_max3_f32 v126, v126, v41, v42
    v_max_f32 v126, v126, v43
    v_mov_b32 v127, v126
    s_nop 1
    v_permlane32_swap_b32 v126, v127
    s_nop 1
    v_max_f32 v126, v126, v127
    v_sub_f32 v12, 0, v126
    v_sub_f32 v13, 0, v126
    v_sub_f32 v14, 0, v126
    v_sub_f32 v15, 0, v126
    v_sub_f32 v16, 0, v126
    v_sub_f32 v17, 0, v126
    v_sub_f32 v18, 0, v126
    v_sub_f32 v19, 0, v126
    v_sub_f32 v20, 0, v126
    v_sub_f32 v21, 0, v126
    v_sub_f32 v22, 0, v126
    v_sub_f32 v23, 0, v126
    v_sub_f32 v24, 0, v126
    v_sub_f32 v25, 0, v126
    v_sub_f32 v26, 0, v126
    v_sub_f32 v27, 0, v126
    v_sub_f32 v28, v28, v126
    v_sub_f32 v29, v29, v126
    v_sub_f32 v30, v30, v126
    v_sub_f32 v31, v31, v126
    v_sub_f32 v32, v32, v126
    v_sub_f32 v33, v33, v126
    v_sub_f32 v34, v34, v126
    v_sub_f32 v35, v35, v126
    v_sub_f32 v36, v36, v126
    v_sub_f32 v37, v37, v126
    v_sub_f32 v38, v38, v126
    v_sub_f32 v39, v39, v126
    v_sub_f32 v40, v40, v126
    v_sub_f32 v41, v41, v126
    v_sub_f32 v42, v42, v126
    v_sub_f32 v43, v43, v126
    s_waitcnt vmcnt(0)
    s_barrier
    s_barrier
    s_branch L_at
L_kl:
    s_waitcnt lgkmcnt(0)
    s_mov_b32 s32, s64
    s_mov_b32 s33, s65
    s_mov_b32 s34, 0x900000
    s_mov_b32 s35, 0x00020000
    s_mov_b32 s40, s62
    s_mov_b32 s41, s63
    s_mov_b32 s42, 0x100
    s_mov_b32 s43, 0x00020000
    s_mov_b32 s28, s58
    s_mov_b32 s29, s59
    s_mov_b32 s30, 0x200000
    s_mov_b32 s31, 0x00020000
    v_lshrrev_b32 v60, 3, v0
    s_lshl_b32 s70, s69, 4
    v_add_u32 v60, s70, v60
    s_movk_i32 s70, 2048
    v_mul_lo_u32 v60, v60, s70
    v_bfe_u32 v61, v0, 4, 1
    v_lshlrev_b32 v61, 2, v61
    v_and_b32 v132, 7, v0
    v_xor_b32 v61, v61, v132
    v_lshl_add_u32 v132, v61, 4, v60
    s_lshl_b32 s70, s68, 7
    v_add_u32 v132, s70, v132
    v_add_u32 v133, 15360, v132
    v_xor_b32 v133, 32, v133
    s_cmp_lg_u32 s66, 0
    s_cbranch_scc1 L_kl_idle
    s_cmp_ge_u32 s68, 8
    s_cbranch_scc1 L_kl_idle
    v_mov_b32 v28, 0
    v_mov_b32 v29, 0
    v_mov_b32 v30, 0
    v_mov_b32 v31, 0
    s_lshl_b32 s70, s67, 3
    s_add_u32 s70, s70, s68
    s_lshl_b32 s70, s70, 10
    s_add_u32 s70, s70, 0x40000
    s_add_u32 s71, s70, 0x20000
    buffer_store_dwordx4 v[28:31], v3, s[32:35], s70 offen sc1
    buffer_store_dwordx4 v[28:31], v3, s[32:35], s71 offen sc1
    v_lshrrev_b32 v96, 4, v0
    v_bfe_u32 v97, v0, 1, 3
    v_xor_b32 v97, v97, v96
    v_lshlrev_b32 v97, 4, v97
    v_and_b32 v98, 15, v0
    s_and_b32 s70, s68, 3
    s_lshl_b32 s70, s70, 12
    s_add_u32 s70, s70, 102400
    v_lshl_add_u32 v4, v98, 7, v97
    v_add_u32 v4, s70, v4
    v_xor_b32 v5, 64, v4
    v_bfe_u32 v97, v0, 2, 2
    v_lshl_add_u32 v97, v96, 3, v97
    v_and_b32 v99, 3, v0
    v_lshlrev_b32 v99, 3, v99
    v_lshl_add_u32 v97, v97, 6, v99
    v_and_b32 v99, 16, v0
    v_lshl_add_u32 v8, v99, 1, v97
    v_add_u32 v8, 102400, v8
    v_xor_b32 v9, 32, v8
    v_lshlrev_b32 v11, 4, v98
    v_lshl_add_u32 v11, v96, 9, v11
    v_and_b32 v99, 8, v0
    v_lshl_add_u32 v10, v99, 4, v11
    v_mov_b32 v12, 0
    v_mov_b32 v13, 0
    v_mov_b32 v14, 0
    v_mov_b32 v15, 0
    v_mov_b32 v16, 0
    v_mov_b32 v17, 0
    v_mov_b32 v18, 0
    v_mov_b32 v19, 0
    v_mov_b32 v20, 0
    v_mov_b32 v21, 0
    v_mov_b32 v22, 0
    v_mov_b32 v23, 0
    v_mov_b32 v24, 0
    v_mov_b32 v25, 0
    v_mov_b32 v26, 0
    v_mov_b32 v27, 0
    s_mov_b32 s77, 102400
    s_mov_b32 s76, 8
    s_barrier
    s_bitcmp1_b32 s68, 2
    s_cbranch_scc1 L_kvw_v
L_kvw_k:
    s_barrier
    ds_read_b128 v[32:35], v4 offset:0
    ds_read_b64_tr_b16 v[40:41], v8 offset:24576
    ds_read_b64_tr_b16 v[42:43], v8 offset:24832
    ds_read_b128 v[36:39], v4 offset:2048
    ds_read_b64_tr_b16 v[44:45], v9 offset:24576
    ds_read_b64_tr_b16 v[46:47], v9 offset:24832
    ds_read_b128 v[48:51], v5 offset:0
    ds_read_b64_tr_b16 v[56:57], v8 offset:26624
    ds_read_b64_tr_b16 v[58:59], v8 offset:26880
    ds_read_b128 v[52:55], v5 offset:2048
    ds_read_b64_tr_b16 v[60:61], v9 offset:26624
    ds_read_b64_tr_b16 v[62:63], v9 offset:26880
L_kvw_k_loop:
    s_mov_b32 s78, 40960
    s_mov_b32 s79, 40960
    s_bitcmp0_b32 s76, 0
    s_cselect_b32 s78, 0xfffe7000, s78
    s_cselect_b32 s79, 0x6000, s79
    v_add_u32 v4, s78, v4
    v_add_u32 v5, s78, v5
    v_add_u32 v8, s79, v8
    v_add_u32 v9, s79, v9
    s_waitcnt lgkmcnt(0)
    s_barrier
    v_mfma_f32_16x16x32_bf16 v[12:15], v[40:43], v[32:35], v[12:15]
    ds_read_b128 v[64:67], v4 offset:0
    ds_read_b64_tr_b16 v[72:73], v8 offset:24576
    v_mfma_f32_16x16x32_bf16 v[16:19], v[44:47], v[32:35], v[16:19]
    ds_read_b64_tr_b16 v[74:75], v8 offset:24832
    ds_read_b128 v[68:71], v4 offset:2048
    v_mfma_f32_16x16x32_bf16 v[20:23], v[40:43], v[36:39], v[20:23]
    ds_read_b64_tr_b16 v[76:77], v9 offset:24576
    ds_read_b64_tr_b16 v[78:79], v9 offset:24832
    v_mfma_f32_16x16x32_bf16 v[24:27], v[44:47], v[36:39], v[24:27]
    ds_read_b128 v[80:83], v5 offset:0
    ds_read_b64_tr_b16 v[88:89], v8 offset:26624
    v_mfma_f32_16x16x32_bf16 v[12:15], v[56:59], v[48:51], v[12:15]
    ds_read_b64_tr_b16 v[90:91], v8 offset:26880
    ds_read_b128 v[84:87], v5 offset:2048
    v_mfma_f32_16x16x32_bf16 v[16:19], v[60:63], v[48:51], v[16:19]
    ds_read_b64_tr_b16 v[92:93], v9 offset:26624
    ds_read_b64_tr_b16 v[94:95], v9 offset:26880
    v_mfma_f32_16x16x32_bf16 v[20:23], v[56:59], v[52:55], v[20:23]
    v_mfma_f32_16x16x32_bf16 v[24:27], v[60:63], v[52:55], v[24:27]
    s_mov_b32 s78, 40960
    s_mov_b32 s79, 40960
    s_bitcmp0_b32 s76, 0
    s_cselect_b32 s78, 0x5000, s78
    s_cselect_b32 s79, 0xfffe6000, s79
    v_add_u32 v4, s78, v4
    v_add_u32 v5, s78, v5
    v_add_u32 v8, s79, v8
    v_add_u32 v9, s79, v9
    s_waitcnt lgkmcnt(0)
    s_barrier
    v_mfma_f32_16x16x32_bf16 v[12:15], v[72:75], v[64:67], v[12:15]
    ds_read_b128 v[32:35], v4 offset:0
    ds_read_b64_tr_b16 v[40:41], v8 offset:24576
    v_mfma_f32_16x16x32_bf16 v[16:19], v[76:79], v[64:67], v[16:19]
    ds_read_b64_tr_b16 v[42:43], v8 offset:24832
    ds_read_b128 v[36:39], v4 offset:2048
    v_mfma_f32_16x16x32_bf16 v[20:23], v[72:75], v[68:71], v[20:23]
    ds_read_b64_tr_b16 v[44:45], v9 offset:24576
    ds_read_b64_tr_b16 v[46:47], v9 offset:24832
    v_mfma_f32_16x16x32_bf16 v[24:27], v[76:79], v[68:71], v[24:27]
    ds_read_b128 v[48:51], v5 offset:0
    ds_read_b64_tr_b16 v[56:57], v8 offset:26624
    v_mfma_f32_16x16x32_bf16 v[12:15], v[88:91], v[80:83], v[12:15]
    ds_read_b64_tr_b16 v[58:59], v8 offset:26880
    ds_read_b128 v[52:55], v5 offset:2048
    v_mfma_f32_16x16x32_bf16 v[16:19], v[92:95], v[80:83], v[16:19]
    ds_read_b64_tr_b16 v[60:61], v9 offset:26624
    ds_read_b64_tr_b16 v[62:63], v9 offset:26880
    v_mfma_f32_16x16x32_bf16 v[20:23], v[88:91], v[84:87], v[20:23]
    v_mfma_f32_16x16x32_bf16 v[24:27], v[92:95], v[84:87], v[24:27]
    s_sub_u32 s76, s76, 1
    s_cmp_lg_u32 s76, 0
    s_cbranch_scc1 L_kvw_k_loop
    s_lshl_b32 s70, s67, 2
    s_and_b32 s71, s68, 3
    s_add_u32 s70, s70, s71
    s_waitcnt lgkmcnt(0)
    s_nop 15
    s_add_u32 s70, s70, 63
    s_and_b32 s70, s70, 63
    s_mov_b32 s72, 0x3e8293ee
    s_mov_b32 s73, 0x3e8293ee
    v_pk_mul_f32 v[12:13], v[12:13], s[72:73]
    v_pk_mul_f32 v[14:15], v[14:15], s[72:73]
    v_pk_mul_f32 v[16:17], v[16:17], s[72:73]
    v_pk_mul_f32 v[18:19], v[18:19], s[72:73]
    v_pk_mul_f32 v[20:21], v[20:21], s[72:73]
    v_pk_mul_f32 v[22:23], v[22:23], s[72:73]
    v_pk_mul_f32 v[24:25], v[24:25], s[72:73]
    v_pk_mul_f32 v[26:27], v[26:27], s[72:73]
    s_lshl_b32 s70, s70, 12
    s_add_u32 s70, s70, 0x0
    v_cvt_pk_bf16_f32 v32, v12, v13
    v_cvt_pk_bf16_f32 v33, v14, v15
    v_cvt_pk_bf16_f32 v34, v16, v17
    v_cvt_pk_bf16_f32 v35, v18, v19
    v_cvt_pk_bf16_f32 v36, v20, v21
    v_cvt_pk_bf16_f32 v37, v22, v23
    v_cvt_pk_bf16_f32 v38, v24, v25
    v_cvt_pk_bf16_f32 v39, v26, v27
    buffer_store_dwordx4 v[32:35], v10, s[32:35], s70 offen offset:0 sc1
    buffer_store_dwordx4 v[36:39], v10, s[32:35], s70 offen offset:128 sc1
    s_branch L_kvw_st
L_kvw_v:
    s_barrier
    ds_read_b128 v[32:35], v4 offset:0
    ds_read_b64_tr_b16 v[40:41], v8 offset:24576
    ds_read_b64_tr_b16 v[42:43], v8 offset:24832
    ds_read_b128 v[36:39], v4 offset:2048
    ds_read_b64_tr_b16 v[44:45], v9 offset:24576
    ds_read_b64_tr_b16 v[46:47], v9 offset:24832
    ds_read_b128 v[48:51], v5 offset:0
    ds_read_b64_tr_b16 v[56:57], v8 offset:26624
    ds_read_b64_tr_b16 v[58:59], v8 offset:26880
    ds_read_b128 v[52:55], v5 offset:2048
    ds_read_b64_tr_b16 v[60:61], v9 offset:26624
    ds_read_b64_tr_b16 v[62:63], v9 offset:26880
L_kvw_v_loop:
    s_mov_b32 s78, 40960
    s_mov_b32 s79, 40960
    s_bitcmp0_b32 s76, 0
    s_cselect_b32 s78, 0xfffe7000, s78
    s_cselect_b32 s79, 0x6000, s79
    v_add_u32 v4, s78, v4
    v_add_u32 v5, s78, v5
    v_add_u32 v8, s79, v8
    v_add_u32 v9, s79, v9
    s_waitcnt lgkmcnt(0)
    s_barrier
    v_mfma_f32_16x16x32_bf16 v[12:15], v[32:35], v[40:43], v[12:15]
    ds_read_b128 v[64:67], v4 offset:0
    ds_read_b64_tr_b16 v[72:73], v8 offset:24576
    v_mfma_f32_16x16x32_bf16 v[16:19], v[36:39], v[40:43], v[16:19]
    ds_read_b64_tr_b16 v[74:75], v8 offset:24832
    ds_read_b128 v[68:71], v4 offset:2048
    v_mfma_f32_16x16x32_bf16 v[20:23], v[32:35], v[44:47], v[20:23]
    ds_read_b64_tr_b16 v[76:77], v9 offset:24576
    ds_read_b64_tr_b16 v[78:79], v9 offset:24832
    v_mfma_f32_16x16x32_bf16 v[24:27], v[36:39], v[44:47], v[24:27]
    ds_read_b128 v[80:83], v5 offset:0
    ds_read_b64_tr_b16 v[88:89], v8 offset:26624
    v_mfma_f32_16x16x32_bf16 v[12:15], v[48:51], v[56:59], v[12:15]
    ds_read_b64_tr_b16 v[90:91], v8 offset:26880
    ds_read_b128 v[84:87], v5 offset:2048
    v_mfma_f32_16x16x32_bf16 v[16:19], v[52:55], v[56:59], v[16:19]
    ds_read_b64_tr_b16 v[92:93], v9 offset:26624
    ds_read_b64_tr_b16 v[94:95], v9 offset:26880
    v_mfma_f32_16x16x32_bf16 v[20:23], v[48:51], v[60:63], v[20:23]
    v_mfma_f32_16x16x32_bf16 v[24:27], v[52:55], v[60:63], v[24:27]
    s_mov_b32 s78, 40960
    s_mov_b32 s79, 40960
    s_bitcmp0_b32 s76, 0
    s_cselect_b32 s78, 0x5000, s78
    s_cselect_b32 s79, 0xfffe6000, s79
    v_add_u32 v4, s78, v4
    v_add_u32 v5, s78, v5
    v_add_u32 v8, s79, v8
    v_add_u32 v9, s79, v9
    s_waitcnt lgkmcnt(0)
    s_barrier
    v_mfma_f32_16x16x32_bf16 v[12:15], v[64:67], v[72:75], v[12:15]
    ds_read_b128 v[32:35], v4 offset:0
    ds_read_b64_tr_b16 v[40:41], v8 offset:24576
    v_mfma_f32_16x16x32_bf16 v[16:19], v[68:71], v[72:75], v[16:19]
    ds_read_b64_tr_b16 v[42:43], v8 offset:24832
    ds_read_b128 v[36:39], v4 offset:2048
    v_mfma_f32_16x16x32_bf16 v[20:23], v[64:67], v[76:79], v[20:23]
    ds_read_b64_tr_b16 v[44:45], v9 offset:24576
    ds_read_b64_tr_b16 v[46:47], v9 offset:24832
    v_mfma_f32_16x16x32_bf16 v[24:27], v[68:71], v[76:79], v[24:27]
    ds_read_b128 v[48:51], v5 offset:0
    ds_read_b64_tr_b16 v[56:57], v8 offset:26624
    v_mfma_f32_16x16x32_bf16 v[12:15], v[80:83], v[88:91], v[12:15]
    ds_read_b64_tr_b16 v[58:59], v8 offset:26880
    ds_read_b128 v[52:55], v5 offset:2048
    v_mfma_f32_16x16x32_bf16 v[16:19], v[84:87], v[88:91], v[16:19]
    ds_read_b64_tr_b16 v[60:61], v9 offset:26624
    ds_read_b64_tr_b16 v[62:63], v9 offset:26880
    v_mfma_f32_16x16x32_bf16 v[20:23], v[80:83], v[92:95], v[20:23]
    v_mfma_f32_16x16x32_bf16 v[24:27], v[84:87], v[92:95], v[24:27]
    s_sub_u32 s76, s76, 1
    s_cmp_lg_u32 s76, 0
    s_cbranch_scc1 L_kvw_v_loop
    s_lshl_b32 s70, s67, 2
    s_and_b32 s71, s68, 3
    s_add_u32 s70, s70, s71
    s_waitcnt lgkmcnt(0)
    s_nop 15
    s_lshl_b32 s70, s70, 12
    s_add_u32 s70, s70, 0x800
    v_cvt_pk_bf16_f32 v32, v12, v13
    v_cvt_pk_bf16_f32 v33, v14, v15
    v_cvt_pk_bf16_f32 v34, v16, v17
    v_cvt_pk_bf16_f32 v35, v18, v19
    v_cvt_pk_bf16_f32 v36, v20, v21
    v_cvt_pk_bf16_f32 v37, v22, v23
    v_cvt_pk_bf16_f32 v38, v24, v25
    v_cvt_pk_bf16_f32 v39, v26, v27
    buffer_store_dwordx4 v[32:35], v11, s[32:35], s70 offen offset:0 sc1
    buffer_store_dwordx4 v[36:39], v11, s[32:35], s70 offen offset:256 sc1
L_kvw_st:
    s_barrier
    s_barrier
    s_waitcnt vmcnt(0)
    v_mov_b32 v125, 1
    s_mov_b64 exec, 1
    buffer_atomic_add v125, off, s[40:43], 0
    s_mov_b64 exec, -1
    s_barrier
    s_barrier
    s_branch L_kl_mid
L_kl_idle:
    s_mov_b32 s16, s46
    s_mov_b32 s17, s47
    s_mov_b32 s18, 0x600000
    s_mov_b32 s19, 0x00020000
    s_lshr_b32 s70, s2, 3
    s_mul_i32 s70, s70, 12288
    s_and_b32 s71, s68, 8
    s_or_b32 s71, s71, 3
    s_lshl_b32 s71, s71, 7
    s_add_u32 s70, s70, s71
    s_sub_u32 s71, s69, 1
    s_lshl_b32 s71, s71, 11
    s_add_u32 s70, s70, s71
    s_mov_b32 s4, s50
    s_mov_b32 s5, s51
    s_mov_b32 s6, 0x400000
    s_mov_b32 s7, 0x00020000
    s_mov_b32 s12, s52
    s_mov_b32 s13, s53
    s_mov_b32 s14, 0x200000
    s_mov_b32 s15, 0x00020000
    s_mov_b32 s8, s44
    s_mov_b32 s9, s45
    s_mov_b32 s10, 0x400000
    s_mov_b32 s11, 0x00020000
    s_lshr_b32 s77, s67, 2
    s_lshr_b32 s78, s68, 3
    s_lshr_b32 s79, s2, 3
    v_lshrrev_b32 v4, 3, v0
    v_and_b32 v5, 7, v0
    v_lshlrev_b32 v5, 7, v5
    s_lshl_b32 s80, s77, 9
    s_lshl_b32 s81, s78, 8
    s_add_u32 s80, s80, s81
    s_lshl_b32 s81, s79, 3
    s_add_u32 s80, s80, s81
    v_add_u32 v6, s80, v4
    v_lshl_add_u32 v6, v6, 11, v5
    s_lshl_b32 s80, s77, 5
    s_add_u32 s80, s80, s79
    v_lshlrev_b32 v7, 7, v4
    v_add_u32 v7, s80, v7
    s_lshl_b32 s81, s78, 10
    v_add_u32 v5, s81, v5
    v_lshl_add_u32 v7, v7, 11, v5
    v_and_b32 v8, 1, v4
    v_lshlrev_b32 v8, 7, v8
    v_add_u32 v8, s80, v8
    v_mul_u32_u24 v8, 6144, v8
    v_add_u32 v8, v8, v5
    v_lshrrev_b32 v10, 1, v4
    v_lshl_add_u32 v8, v10, 11, v8
    v_cmp_eq_u32 vcc, 3, v10
    v_mov_b32 v10, 0x7000000
    s_nop 1
    v_cndmask_b32 v8, v8, v10, vcc
    s_barrier
    s_cmp_lg_u32 s69, 1
    s_cbranch_scc1 Ltch1
    buffer_load_dword v9, v6, s[4:7], 0 offen
Ltch1:
    s_cmp_lg_u32 s69, 2
    s_cbranch_scc1 Ltch2
    buffer_load_dword v9, v7, s[12:15], 0 offen
Ltch2:
    s_cmp_lg_u32 s69, 3
    s_cbranch_scc1 Ltch3
    buffer_load_dword v9, v6, s[4:7], 0 offen offset:1024
Ltch3:
    s_lshr_b32 s83, s67, 2
    s_mul_i32 s83, s83, 4
    s_lshr_b32 s82, s68, 3
    s_mul_i32 s82, s82, 8
    s_add_u32 s83, s83, s82
    s_add_u32 s83, s83, 4
    s_mov_b32 s76, 0
L_kl_b:
    s_barrier
    s_lshl_b32 s80, s76, 2
    s_add_u32 s80, s80, s69
    s_cmp_eq_u32 s69, 0
    s_cbranch_scc1 L_kl_nt
    s_sub_u32 s81, s76, 8
    s_mul_i32 s81, s81, 2
    s_cmp_ge_u32 s81, 16
    s_cbranch_scc1 L_kl_nt
    s_add_u32 s71, s81, s83
    s_add_u32 s71, s71, 0
    s_and_b32 s71, s71, 15
    s_mul_i32 s82, s71, 393216
    s_add_u32 s82, s82, s70
    s_add_u32 s71, s82, 0
    s_buffer_load_dword s72, s[16:19], s71
    s_add_u32 s71, s82, 64
    s_buffer_load_dword s73, s[16:19], s71
    s_add_u32 s71, s82, 6144
    s_buffer_load_dword s74, s[16:19], s71
    s_add_u32 s71, s82, 6208
    s_buffer_load_dword s75, s[16:19], s71
    s_add_u32 s71, s81, s83
    s_add_u32 s71, s71, 1
    s_and_b32 s71, s71, 15
    s_mul_i32 s82, s71, 393216
    s_add_u32 s82, s82, s70
    s_add_u32 s71, s82, 0
    s_buffer_load_dword s72, s[16:19], s71
    s_add_u32 s71, s82, 64
    s_buffer_load_dword s73, s[16:19], s71
    s_add_u32 s71, s82, 6144
    s_buffer_load_dword s74, s[16:19], s71
    s_add_u32 s71, s82, 6208
    s_buffer_load_dword s75, s[16:19], s71
L_kl_nt:
    s_add_u32 s76, s76, 1
    s_cmp_lt_u32 s76, 21
    s_cbranch_scc1 L_kl_b
L_kl_mid:
    s_waitcnt vmcnt(0)
    s_lshl_b32 s70, s66, 11
    s_add_u32 s70, s70, 143360
    v_add_u32 v125, s70, v3
    ds_read_b128 v[4:7], v125 offset:0
    ds_read_b128 v[8:11], v125 offset:1024
    s_waitcnt lgkmcnt(0)
    v_and_b32 v126, 4, v0
    v_cmp_eq_u32 vcc, 0, v126
    v_mov_b32 v127, 0x3f803f80
    v_mov_b32 v100, 0
    v_mov_b32 v101, 0
    v_mov_b32 v102, 0
    v_mov_b32 v103, 0
    v_mov_b32 v104, 0
    v_mov_b32 v105, 0
    v_mov_b32 v106, 0
    v_mov_b32 v107, 0
    v_mov_b32 v108, 0
    v_mov_b32 v109, 0
    v_mov_b32 v110, 0
    v_mov_b32 v111, 0
    v_mov_b32 v112, 0
    v_mov_b32 v113, 0
    v_mov_b32 v114, 0
    v_mov_b32 v115, 0
    v_cndmask_b32 v120, 0, v127, vcc
    v_mov_b32 v121, v120
    v_xor_b32 v122, v120, v127
    v_mov_b32 v123, v122
    v_and_b32 v126, 1, v0
    v_mul_u32_u24 v1, 0xaaaa, v126
    v_add_u32 v1, 0x4444, v1
    v_mov_b32 v116, 0
    v_mov_b32 v117, 0
    v_mov_b32 v118, 0
    v_mov_b32 v119, 0
    v_mov_b32 v60, 0
    v_mov_b32 v61, 0
    v_mov_b32 v62, 0
    v_mov_b32 v63, 0
    v_mov_b32 v64, 0
    v_mov_b32 v65, 0
    v_mov_b32 v66, 0
    v_mov_b32 v67, 0
    v_mov_b32 v96, 0
    v_mov_b32 v97, 0
    v_mov_b32 v98, 0
    v_mov_b32 v99, 0
    v_mov_b32 v124, v3
    s_barrier
    s_barrier
    s_barrier
    s_cmp_lg_u32 s69, 1
    s_cbranch_scc1 L_kl_l
    buffer_load_dword v125, off, s[40:43], 0 sc1
L_kl_l:
    s_barrier
    s_cmp_lg_u32 s69, 1
    s_cbranch_scc1 L_kl_ok
    s_waitcnt vmcnt(0)
    v_readfirstlane_b32 s70, v125
    s_nop 3
    s_cmp_ge_u32 s70, 128
    s_cbranch_scc1 L_kl_ok
    s_mov_b32 s70, 262144
Lpoll4:
    buffer_load_dword v125, off, s[40:43], 0 sc1
    s_waitcnt vmcnt(0)
    v_readfirstlane_b32 s71, v125
    s_nop 3
    s_cmp_ge_u32 s71, 128
    s_cbranch_scc1 Lpdone5
    s_sleep 4
    s_sub_u32 s70, s70, 1
    s_cmp_lg_u32 s70, 0
    s_cbranch_scc1 Lpoll4
Lpdone5:
L_kl_ok:
    s_barrier
    s_lshl_b32 s73, s69, 10
    s_add_u32 s74, s73, 0x0
    s_add_u32 m0, s73, 143360
    s_add_u32 s75, s74, 258048
    buffer_load_dwordx4 v3, s[32:35], s75 offen sc1 lds
    s_add_u32 m0, s73, 159744
    s_add_u32 s75, s74, 0
    buffer_load_dwordx4 v3, s[32:35], s75 offen sc1 lds
    s_barrier
    s_add_u32 m0, s73, 0
    s_add_u32 s75, s74, 4096
    buffer_load_dwordx4 v3, s[32:35], s75 offen sc1 lds
    s_add_u32 m0, s73, 4096
    s_add_u32 s75, s74, 8192
    buffer_load_dwordx4 v3, s[32:35], s75 offen sc1 lds
    s_barrier
    s_waitcnt vmcnt(2)
    s_barrier
    s_add_u32 m0, s73, 8192
    s_add_u32 s75, s74, 12288
    buffer_load_dwordx4 v3, s[32:35], s75 offen sc1 lds
    s_add_u32 m0, s73, 12288
    s_add_u32 s75, s74, 16384
    buffer_load_dwordx4 v3, s[32:35], s75 offen sc1 lds
    s_add_u32 m0, s73, 16384
    s_add_u32 s75, s74, 20480
    buffer_load_dwordx4 v3, s[32:35], s75 offen sc1 lds
    v_add_u32 v125, 143360, v3
    ds_read_b128 v[84:87], v125 offset:0
    ds_read_b128 v[88:91], v125 offset:1024
    ds_read_b128 v[68:71], v125 offset:16384
    ds_read_b128 v[72:75], v125 offset:17408
    ds_read_b128 v[76:79], v125 offset:18432
    ds_read_b128 v[80:83], v125 offset:19456
    s_waitcnt lgkmcnt(0)
    s_setprio 3
    v_mfma_f32_32x32x16_bf16 v[28:43], v[84:87], v[4:7], 0
    v_mfma_f32_32x32x16_bf16 v[28:43], v[88:91], v[8:11], v[28:43]
    s_setprio 0
    s_nop 15
    v_max3_f32 v126, v28, v29, v30
    v_max3_f32 v126, v126, v31, v32
    v_max3_f32 v126, v126, v33, v34
    v_max3_f32 v126, v126, v35, v36
    v_max3_f32 v126, v126, v37, v38
    v_max3_f32 v126, v126, v39, v40
    v_max3_f32 v126, v126, v41, v42
    v_max_f32 v126, v126, v43
    v_mov_b32 v127, v126
    s_nop 1
    v_permlane32_swap_b32 v126, v127
    s_nop 1
    v_max_f32 v126, v126, v127
    v_sub_f32 v12, 0, v126
    v_sub_f32 v13, 0, v126
    v_sub_f32 v14, 0, v126
    v_sub_f32 v15, 0, v126
    v_sub_f32 v16, 0, v126
    v_sub_f32 v17, 0, v126
    v_sub_f32 v18, 0, v126
    v_sub_f32 v19, 0, v126
    v_sub_f32 v20, 0, v126
    v_sub_f32 v21, 0, v126
    v_sub_f32 v22, 0, v126
    v_sub_f32 v23, 0, v126
    v_sub_f32 v24, 0, v126
    v_sub_f32 v25, 0, v126
    v_sub_f32 v26, 0, v126
    v_sub_f32 v27, 0, v126
    v_sub_f32 v28, v28, v126
    v_sub_f32 v29, v29, v126
    v_sub_f32 v30, v30, v126
    v_sub_f32 v31, v31, v126
    v_sub_f32 v32, v32, v126
    v_sub_f32 v33, v33, v126
    v_sub_f32 v34, v34, v126
    v_sub_f32 v35, v35, v126
    v_sub_f32 v36, v36, v126
    v_sub_f32 v37, v37, v126
    v_sub_f32 v38, v38, v126
    v_sub_f32 v39, v39, v126
    v_sub_f32 v40, v40, v126
    v_sub_f32 v41, v41, v126
    v_sub_f32 v42, v42, v126
    v_sub_f32 v43, v43, v126
    s_barrier
    s_barrier
    s_add_u32 m0, s73, 20480
    s_add_u32 s75, s74, 24576
    buffer_load_dwordx4 v3, s[32:35], s75 offen sc1 lds
    s_add_u32 m0, s73, 24576
    s_add_u32 s75, s74, 28672
    buffer_load_dwordx4 v3, s[32:35], s75 offen sc1 lds
    s_add_u32 m0, s73, 28672
    s_add_u32 s75, s74, 32768
    buffer_load_dwordx4 v3, s[32:35], s75 offen sc1 lds
    s_add_u32 m0, s73, 32768
    s_add_u32 s75, s74, 36864
    buffer_load_dwordx4 v3, s[32:35], s75 offen sc1 lds
    s_add_u32 m0, s73, 36864
    s_add_u32 s75, s74, 40960
    buffer_load_dwordx4 v3, s[32:35], s75 offen sc1 lds
    s_add_u32 m0, s73, 40960
    s_add_u32 s75, s74, 45056
    buffer_load_dwordx4 v3, s[32:35], s75 offen sc1 lds
    s_add_u32 m0, s73, 45056
    s_add_u32 s75, s74, 49152
    buffer_load_dwordx4 v3, s[32:35], s75 offen sc1 lds
    s_add_u32 m0, s73, 49152
    s_add_u32 s75, s74, 53248
    buffer_load_dwordx4 v3, s[32:35], s75 offen sc1 lds
    s_add_u32 m0, s73, 53248
    s_add_u32 s75, s74, 57344
    buffer_load_dwordx4 v3, s[32:35], s75 offen sc1 lds
    s_add_u32 m0, s73, 57344
    s_add_u32 s75, s74, 61440
    buffer_load_dwordx4 v3, s[32:35], s75 offen sc1 lds
    s_barrier
    s_add_u32 m0, s73, 61440
    s_add_u32 s75, s74, 65536
    buffer_load_dwordx4 v3, s[32:35], s75 offen sc1 lds
    s_add_u32 m0, s73, 65536
    s_add_u32 s75, s74, 69632
    buffer_load_dwordx4 v3, s[32:35], s75 offen sc1 lds
    s_add_u32 m0, s73, 69632
    s_add_u32 s75, s74, 73728
    buffer_load_dwordx4 v3, s[32:35], s75 offen sc1 lds
    s_add_u32 m0, s73, 73728
    s_add_u32 s75, s74, 77824
    buffer_load_dwordx4 v3, s[32:35], s75 offen sc1 lds
    s_add_u32 m0, s73, 77824
    s_add_u32 s75, s74, 81920
    buffer_load_dwordx4 v3, s[32:35], s75 offen sc1 lds
    s_add_u32 m0, s73, 81920
    s_add_u32 s75, s74, 86016
    buffer_load_dwordx4 v3, s[32:35], s75 offen sc1 lds
    s_add_u32 m0, s73, 86016
    s_add_u32 s75, s74, 90112
    buffer_load_dwordx4 v3, s[32:35], s75 offen sc1 lds
    s_add_u32 m0, s73, 90112
    s_add_u32 s75, s74, 94208
    buffer_load_dwordx4 v3, s[32:35], s75 offen sc1 lds
    s_add_u32 m0, s73, 94208
    s_add_u32 s75, s74, 98304
    buffer_load_dwordx4 v3, s[32:35], s75 offen sc1 lds
    s_add_u32 m0, s73, 98304
    s_add_u32 s75, s74, 102400
    buffer_load_dwordx4 v3, s[32:35], s75 offen sc1 lds
    s_waitcnt vmcnt(10)
    s_barrier
    s_add_u32 m0, s73, 102400
    s_add_u32 s75, s74, 106496
    buffer_load_dwordx4 v3, s[32:35], s75 offen sc1 lds
    s_add_u32 m0, s73, 106496
    s_add_u32 s75, s74, 110592
    buffer_load_dwordx4 v3, s[32:35], s75 offen sc1 lds
    s_add_u32 m0, s73, 110592
    s_add_u32 s75, s74, 114688
    buffer_load_dwordx4 v3, s[32:35], s75 offen sc1 lds
    s_add_u32 m0, s73, 114688
    s_add_u32 s75, s74, 118784
    buffer_load_dwordx4 v3, s[32:35], s75 offen sc1 lds
    s_add_u32 m0, s73, 118784
    s_add_u32 s75, s74, 122880
    buffer_load_dwordx4 v3, s[32:35], s75 offen sc1 lds
    s_add_u32 m0, s73, 122880
    s_add_u32 s75, s74, 126976
    buffer_load_dwordx4 v3, s[32:35], s75 offen sc1 lds
    s_add_u32 m0, s73, 126976
    s_add_u32 s75, s74, 131072
    buffer_load_dwordx4 v3, s[32:35], s75 offen sc1 lds
    s_add_u32 m0, s73, 131072
    s_add_u32 s75, s74, 135168
    buffer_load_dwordx4 v3, s[32:35], s75 offen sc1 lds
    s_add_u32 m0, s73, 135168
    s_add_u32 s75, s74, 139264
    buffer_load_dwordx4 v3, s[32:35], s75 offen sc1 lds
    s_add_u32 m0, s73, 139264
    s_add_u32 s75, s74, 143360
    buffer_load_dwordx4 v3, s[32:35], s75 offen sc1 lds
L_at:
    s_lshl_b32 s70, s67, 5
    s_lshl_b32 s71, s68, 1
    s_add_u32 s70, s70, s71
    s_and_b32 s71, s66, 1
    s_add_u32 s70, s70, s71
    s_lshl_b32 s70, s70, 2
    s_lshr_b32 s71, s66, 1
    s_add_u32 s70, s70, s71
    s_lshl_b32 s70, s70, 11
    s_add_u32 s79, s70, 0x500000
    s_mul_i32 s80, s67, 1152
    s_add_u32 s80, s80, 0x6e000
    s_mov_b64 s[72:73], 0
    v_xor_b32 v133, 32, v133
    v_and_b32 v126, 32, v0
    v_xor_b32 v132, v132, v126
    v_xor_b32 v133, v133, v126
    s_cmp_lt_u32 s66, 4
    s_cselect_b32 s74, 2, 4
    s_mov_b32 s76, 0
    s_mov_b32 s77, 0
    s_movk_i32 s78, 0xfa
.p2align 6
L_at_loop:
    s_bitcmp1_b32 s78, s76
    s_cbranch_scc0 L_at_nb
    s_waitcnt vmcnt(0)
    s_barrier
L_at_nb:
    s_cmp_eq_u32 s76, s74
    s_cbranch_scc1 L_wget
L_wget_b:
    v_mfma_f32_32x32x16_bf16 v[44:59], v[68:71], v[4:7], v[12:27]
    ds_read_b128 v[84:87], v124 offset:0
    v_exp_f32 v28, v28
    v_exp_f32 v29, v29
    v_exp_f32 v30, v30
    v_exp_f32 v31, v31
    v_mfma_f32_32x32x16_bf16 v[100:115], v[96:99], v[64:67], v[100:115]
    ds_read_b128 v[88:91], v124 offset:1024
    v_exp_f32 v32, v32
    v_exp_f32 v33, v33
    v_exp_f32 v34, v34
    v_exp_f32 v35, v35
    v_smfmac_f32_16x16x64_bf16 v[116:119], v[120:123], v[60:67], v1
    ds_read_b128 v[92:95], v124 offset:2048
    ds_read_b128 v[96:99], v124 offset:3072
    v_exp_f32 v36, v36
    v_exp_f32 v37, v37
    v_cvt_pk_bf16_f32 v60, v28, v29
    v_cvt_pk_bf16_f32 v61, v30, v31
    v_cvt_pk_bf16_f32 v62, v32, v33
    v_cvt_pk_bf16_f32 v63, v34, v35
    v_mfma_f32_32x32x16_bf16 v[44:59], v[72:75], v[8:11], v[44:59]
    v_exp_f32 v38, v38
    v_exp_f32 v39, v39
    v_exp_f32 v40, v40
    v_exp_f32 v41, v41
    v_mfma_f32_32x32x16_bf16 v[100:115], v[76:79], v[60:63], v[100:115]
    s_waitcnt lgkmcnt(0)
    v_exp_f32 v42, v42
    v_exp_f32 v43, v43
    v_cvt_pk_bf16_f32 v64, v36, v37
    v_cvt_pk_bf16_f32 v65, v38, v39
    v_cvt_pk_bf16_f32 v66, v40, v41
    v_cvt_pk_bf16_f32 v67, v42, v43
    v_mfma_f32_32x32x16_bf16 v[28:43], v[84:87], v[4:7], v[12:27]
    ds_read_b128 v[68:71], v124 offset:4096
    v_exp_f32 v44, v44
    v_exp_f32 v45, v45
    v_exp_f32 v46, v46
    v_exp_f32 v47, v47
    v_mfma_f32_32x32x16_bf16 v[100:115], v[80:83], v[64:67], v[100:115]
    ds_read_b128 v[72:75], v124 offset:5120
    v_exp_f32 v48, v48
    v_exp_f32 v49, v49
    v_exp_f32 v50, v50
    v_exp_f32 v51, v51
    v_smfmac_f32_16x16x64_bf16 v[116:119], v[120:123], v[60:67], v1
    ds_read_b128 v[76:79], v124 offset:6144
    ds_read_b128 v[80:83], v124 offset:7168
    v_exp_f32 v52, v52
    v_exp_f32 v53, v53
    v_cvt_pk_bf16_f32 v60, v44, v45
    v_cvt_pk_bf16_f32 v61, v46, v47
    v_cvt_pk_bf16_f32 v62, v48, v49
    v_cvt_pk_bf16_f32 v63, v50, v51
    v_mfma_f32_32x32x16_bf16 v[28:43], v[88:91], v[8:11], v[28:43]
    v_exp_f32 v54, v54
    v_exp_f32 v55, v55
    v_exp_f32 v56, v56
    v_exp_f32 v57, v57
    v_mfma_f32_32x32x16_bf16 v[100:115], v[92:95], v[60:63], v[100:115]
    s_waitcnt lgkmcnt(0)
    v_exp_f32 v58, v58
    v_exp_f32 v59, v59
    v_cvt_pk_bf16_f32 v64, v52, v53
    v_cvt_pk_bf16_f32 v65, v54, v55
    v_cvt_pk_bf16_f32 v66, v56, v57
    v_cvt_pk_bf16_f32 v67, v58, v59
    v_mfma_f32_32x32x16_bf16 v[44:59], v[68:71], v[4:7], v[12:27]
    ds_read_b128 v[84:87], v124 offset:8192
    v_exp_f32 v28, v28
    v_exp_f32 v29, v29
    v_exp_f32 v30, v30
    v_exp_f32 v31, v31
    v_mfma_f32_32x32x16_bf16 v[100:115], v[96:99], v[64:67], v[100:115]
    ds_read_b128 v[88:91], v124 offset:9216
    v_exp_f32 v32, v32
    v_exp_f32 v33, v33
    v_exp_f32 v34, v34
    v_exp_f32 v35, v35
    v_smfmac_f32_16x16x64_bf16 v[116:119], v[120:123], v[60:67], v1
    ds_read_b128 v[92:95], v124 offset:10240
    ds_read_b128 v[96:99], v124 offset:11264
    v_exp_f32 v36, v36
    v_exp_f32 v37, v37
    v_cvt_pk_bf16_f32 v60, v28, v29
    v_cvt_pk_bf16_f32 v61, v30, v31
    v_cvt_pk_bf16_f32 v62, v32, v33
    v_cvt_pk_bf16_f32 v63, v34, v35
    v_mfma_f32_32x32x16_bf16 v[44:59], v[72:75], v[8:11], v[44:59]
    v_exp_f32 v38, v38
    v_exp_f32 v39, v39
    v_exp_f32 v40, v40
    v_exp_f32 v41, v41
    v_mfma_f32_32x32x16_bf16 v[100:115], v[76:79], v[60:63], v[100:115]
    s_waitcnt lgkmcnt(0)
    v_exp_f32 v42, v42
    v_exp_f32 v43, v43
    v_cvt_pk_bf16_f32 v64, v36, v37
    v_cvt_pk_bf16_f32 v65, v38, v39
    v_cvt_pk_bf16_f32 v66, v40, v41
    v_cvt_pk_bf16_f32 v67, v42, v43
    v_mfma_f32_32x32x16_bf16 v[28:43], v[84:87], v[4:7], v[12:27]
    ds_read_b128 v[68:71], v124 offset:12288
    v_exp_f32 v44, v44
    v_exp_f32 v45, v45
    v_exp_f32 v46, v46
    v_exp_f32 v47, v47
    v_mfma_f32_32x32x16_bf16 v[100:115], v[80:83], v[64:67], v[100:115]
    ds_read_b128 v[72:75], v124 offset:13312
    v_exp_f32 v48, v48
    v_exp_f32 v49, v49
    v_exp_f32 v50, v50
    v_exp_f32 v51, v51
    v_smfmac_f32_16x16x64_bf16 v[116:119], v[120:123], v[60:67], v1
    ds_read_b128 v[76:79], v124 offset:14336
    ds_read_b128 v[80:83], v124 offset:15360
    v_exp_f32 v52, v52
    v_exp_f32 v53, v53
    v_cvt_pk_bf16_f32 v60, v44, v45
    v_cvt_pk_bf16_f32 v61, v46, v47
    v_cvt_pk_bf16_f32 v62, v48, v49
    v_cvt_pk_bf16_f32 v63, v50, v51
    v_mfma_f32_32x32x16_bf16 v[28:43], v[88:91], v[8:11], v[28:43]
    v_exp_f32 v54, v54
    v_exp_f32 v55, v55
    v_exp_f32 v56, v56
    v_exp_f32 v57, v57
    v_mfma_f32_32x32x16_bf16 v[100:115], v[92:95], v[60:63], v[100:115]
    s_waitcnt lgkmcnt(0)
    v_exp_f32 v58, v58
    v_exp_f32 v59, v59
    v_cvt_pk_bf16_f32 v64, v52, v53
    v_cvt_pk_bf16_f32 v65, v54, v55
    v_cvt_pk_bf16_f32 v66, v56, v57
    v_cvt_pk_bf16_f32 v67, v58, v59
    v_mfma_f32_32x32x16_bf16 v[44:59], v[68:71], v[4:7], v[12:27]
    ds_read_b128 v[84:87], v124 offset:16384
    v_exp_f32 v28, v28
    v_exp_f32 v29, v29
    v_exp_f32 v30, v30
    v_exp_f32 v31, v31
    v_mfma_f32_32x32x16_bf16 v[100:115], v[96:99], v[64:67], v[100:115]
    ds_read_b128 v[88:91], v124 offset:17408
    v_exp_f32 v32, v32
    v_exp_f32 v33, v33
    v_exp_f32 v34, v34
    v_exp_f32 v35, v35
    v_smfmac_f32_16x16x64_bf16 v[116:119], v[120:123], v[60:67], v1
    ds_read_b128 v[92:95], v124 offset:18432
    ds_read_b128 v[96:99], v124 offset:19456
    v_exp_f32 v36, v36
    v_exp_f32 v37, v37
    v_cvt_pk_bf16_f32 v60, v28, v29
    v_cvt_pk_bf16_f32 v61, v30, v31
    v_cvt_pk_bf16_f32 v62, v32, v33
    v_cvt_pk_bf16_f32 v63, v34, v35
    v_mfma_f32_32x32x16_bf16 v[44:59], v[72:75], v[8:11], v[44:59]
    v_exp_f32 v38, v38
    v_exp_f32 v39, v39
    v_exp_f32 v40, v40
    v_exp_f32 v41, v41
    v_mfma_f32_32x32x16_bf16 v[100:115], v[76:79], v[60:63], v[100:115]
    s_waitcnt lgkmcnt(0)
    v_exp_f32 v42, v42
    v_exp_f32 v43, v43
    v_cvt_pk_bf16_f32 v64, v36, v37
    v_cvt_pk_bf16_f32 v65, v38, v39
    v_cvt_pk_bf16_f32 v66, v40, v41
    v_cvt_pk_bf16_f32 v67, v42, v43
    v_mfma_f32_32x32x16_bf16 v[28:43], v[84:87], v[4:7], v[12:27]
    ds_read_b128 v[68:71], v124 offset:20480
    v_exp_f32 v44, v44
    v_exp_f32 v45, v45
    v_exp_f32 v46, v46
    v_exp_f32 v47, v47
    v_mfma_f32_32x32x16_bf16 v[100:115], v[80:83], v[64:67], v[100:115]
    ds_read_b128 v[72:75], v124 offset:21504
    v_exp_f32 v48, v48
    v_exp_f32 v49, v49
    v_exp_f32 v50, v50
    v_exp_f32 v51, v51
    v_smfmac_f32_16x16x64_bf16 v[116:119], v[120:123], v[60:67], v1
    ds_read_b128 v[76:79], v124 offset:22528
    ds_read_b128 v[80:83], v124 offset:23552
    v_exp_f32 v52, v52
    v_exp_f32 v53, v53
    v_cvt_pk_bf16_f32 v60, v44, v45
    v_cvt_pk_bf16_f32 v61, v46, v47
    v_cvt_pk_bf16_f32 v62, v48, v49
    v_cvt_pk_bf16_f32 v63, v50, v51
    v_mfma_f32_32x32x16_bf16 v[28:43], v[88:91], v[8:11], v[28:43]
    s_setprio 0
    v_exp_f32 v54, v54
    v_exp_f32 v55, v55
    v_exp_f32 v56, v56
    v_exp_f32 v57, v57
    v_mfma_f32_32x32x16_bf16 v[100:115], v[92:95], v[60:63], v[100:115]
    s_waitcnt lgkmcnt(0)
    v_exp_f32 v58, v58
    v_exp_f32 v59, v59
    v_cvt_pk_bf16_f32 v64, v52, v53
    v_cvt_pk_bf16_f32 v65, v54, v55
    v_cvt_pk_bf16_f32 v66, v56, v57
    v_cvt_pk_bf16_f32 v67, v58, v59
    v_mfma_f32_32x32x16_bf16 v[44:59], v[68:71], v[4:7], v[12:27]
    ds_read_b128 v[84:87], v124 offset:24576
    v_exp_f32 v28, v28
    v_exp_f32 v29, v29
    v_exp_f32 v30, v30
    v_exp_f32 v31, v31
    v_mfma_f32_32x32x16_bf16 v[100:115], v[96:99], v[64:67], v[100:115]
    ds_read_b128 v[88:91], v124 offset:25600
    v_exp_f32 v32, v32
    v_exp_f32 v33, v33
    v_exp_f32 v34, v34
    v_exp_f32 v35, v35
    v_smfmac_f32_16x16x64_bf16 v[116:119], v[120:123], v[60:67], v1
    ds_read_b128 v[92:95], v124 offset:26624
    ds_read_b128 v[96:99], v124 offset:27648
    v_exp_f32 v36, v36
    v_exp_f32 v37, v37
    v_cvt_pk_bf16_f32 v60, v28, v29
    v_cvt_pk_bf16_f32 v61, v30, v31
    v_cvt_pk_bf16_f32 v62, v32, v33
    v_cvt_pk_bf16_f32 v63, v34, v35
    v_mfma_f32_32x32x16_bf16 v[44:59], v[72:75], v[8:11], v[44:59]
    v_exp_f32 v38, v38
    v_exp_f32 v39, v39
    v_exp_f32 v40, v40
    v_exp_f32 v41, v41
    v_mfma_f32_32x32x16_bf16 v[100:115], v[76:79], v[60:63], v[100:115]
    s_waitcnt lgkmcnt(0)
    v_exp_f32 v42, v42
    v_exp_f32 v43, v43
    v_cvt_pk_bf16_f32 v64, v36, v37
    v_cvt_pk_bf16_f32 v65, v38, v39
    v_cvt_pk_bf16_f32 v66, v40, v41
    v_cvt_pk_bf16_f32 v67, v42, v43
    v_mfma_f32_32x32x16_bf16 v[28:43], v[84:87], v[4:7], v[12:27]
    ds_read_b128 v[68:71], v124 offset:28672
    v_exp_f32 v44, v44
    v_exp_f32 v45, v45
    v_exp_f32 v46, v46
    v_exp_f32 v47, v47
    v_mfma_f32_32x32x16_bf16 v[100:115], v[80:83], v[64:67], v[100:115]
    ds_read_b128 v[72:75], v124 offset:29696
    v_exp_f32 v48, v48
    v_exp_f32 v49, v49
    v_exp_f32 v50, v50
    v_exp_f32 v51, v51
    v_smfmac_f32_16x16x64_bf16 v[116:119], v[120:123], v[60:67], v1
    ds_read_b128 v[76:79], v124 offset:30720
    ds_read_b128 v[80:83], v124 offset:31744
    v_exp_f32 v52, v52
    v_exp_f32 v53, v53
    v_cvt_pk_bf16_f32 v60, v44, v45
    v_cvt_pk_bf16_f32 v61, v46, v47
    v_cvt_pk_bf16_f32 v62, v48, v49
    v_cvt_pk_bf16_f32 v63, v50, v51
    v_mfma_f32_32x32x16_bf16 v[28:43], v[88:91], v[8:11], v[28:43]
    s_setprio 1
    s_add_u32 s77, s77, 32768
    s_cmp_ge_u32 s77, 163840
    s_cselect_b32 s77, 0, s77
    s_add_u32 s76, s76, 1
    s_cmp_lg_u32 s76, 8
    v_exp_f32 v54, v54
    v_exp_f32 v55, v55
    v_exp_f32 v56, v56
    v_exp_f32 v57, v57
    v_mfma_f32_32x32x16_bf16 v[100:115], v[92:95], v[60:63], v[100:115]
    s_waitcnt lgkmcnt(0)
    v_exp_f32 v58, v58
    v_exp_f32 v59, v59
    v_cvt_pk_bf16_f32 v64, v52, v53
    v_cvt_pk_bf16_f32 v65, v54, v55
    v_cvt_pk_bf16_f32 v66, v56, v57
    v_cvt_pk_bf16_f32 v67, v58, v59
    v_add_u32 v124, s77, v3
    s_cbranch_scc1 L_at_loop
    v_mfma_f32_32x32x16_bf16 v[100:115], v[96:99], v[64:67], v[100:115]
    v_smfmac_f32_16x16x64_bf16 v[116:119], v[120:123], v[60:67], v1
    s_nop 7
    s_nop 3
L_at_fin:
    v_add_f32 v116, v116, v117
    v_rcp_f32 v126, v116
    s_nop 0
    v_mov_b32 v127, v126
    v_pk_mul_f32 v[100:101], v[100:101], v[126:127]
    v_pk_mul_f32 v[102:103], v[102:103], v[126:127]
    v_pk_mul_f32 v[104:105], v[104:105], v[126:127]
    v_pk_mul_f32 v[106:107], v[106:107], v[126:127]
    v_pk_mul_f32 v[108:109], v[108:109], v[126:127]
    v_pk_mul_f32 v[110:111], v[110:111], v[126:127]
    v_pk_mul_f32 v[112:113], v[112:113], v[126:127]
    v_pk_mul_f32 v[114:115], v[114:115], v[126:127]
    v_cvt_pk_bf16_f32 v60, v100, v101
    v_cvt_pk_bf16_f32 v61, v102, v103
    v_cvt_pk_bf16_f32 v62, v104, v105
    v_cvt_pk_bf16_f32 v63, v106, v107
    v_cvt_pk_bf16_f32 v64, v108, v109
    v_cvt_pk_bf16_f32 v65, v110, v111
    v_cvt_pk_bf16_f32 v66, v112, v113
    v_cvt_pk_bf16_f32 v67, v114, v115
    buffer_store_dwordx4 v[60:63], v3, s[32:35], s79 offen offset:0 sc1
    buffer_store_dwordx4 v[64:67], v3, s[32:35], s79 offen offset:1024 sc1
    v_maximum3_f32 v125, abs(v100), abs(v101), abs(v102)
    v_maximum3_f32 v125, v125, abs(v103), abs(v104)
    v_maximum3_f32 v125, v125, abs(v105), abs(v106)
    v_maximum3_f32 v125, v125, abs(v107), abs(v108)
    v_maximum3_f32 v125, v125, abs(v109), abs(v110)
    v_maximum3_f32 v125, v125, abs(v111), abs(v112)
    v_maximum3_f32 v125, v125, abs(v113), abs(v114)
    v_maximum3_f32 v125, v125, abs(v115), abs(v115)
    v_cmp_gt_f32 vcc, 0x53800000, v116
    s_nop 1
    s_mov_b64 s[82:83], vcc
    v_cmp_gt_f32 vcc, 0x7e967699, v125
    s_nop 1
    s_and_b64 vcc, vcc, s[82:83]
    s_or_b64 vcc, vcc, s[72:73]
    s_cmp_eq_u64 vcc, -1
    s_cbranch_scc0 L_slow
    s_lshr_b32 s81, s68, 2
    s_lshl_b32 s81, s81, 8
    s_add_u32 s81, s81, s80
    s_cmp_ge_u32 s66, 4
    s_cbranch_scc1 L_at_ld
    s_waitcnt vmcnt(0)
    v_mov_b32 v125, 1
    s_mov_b64 exec, 1
    buffer_atomic_add v125, off, s[32:35], s81
    s_mov_b64 exec, -1
    s_barrier
    s_lshl_b32 s70, s69, 11
    s_add_u32 s70, s70, 65536
    v_add_u32 v126, s70, v3
    ds_write_b128 v126, v[136:139] offset:0
    ds_write_b128 v126, v[140:143] offset:1024
    ds_write_b128 v126, v[144:147] offset:8192
    ds_write_b128 v126, v[148:151] offset:9216
    ds_write_b128 v126, v[152:155] offset:16384
    ds_write_b128 v126, v[156:159] offset:17408
    ds_write_b128 v126, v[160:163] offset:24576
    ds_write_b128 v126, v[164:167] offset:25600
    s_waitcnt lgkmcnt(0)
    s_cmp_lg_u32 s69, 0
    s_cbranch_scc1 L_at_x
    s_lshr_b32 s81, s68, 2
    s_xor_b32 s81, s81, 2
    s_lshl_b32 s81, s81, 8
    s_add_u32 s81, s81, s80
    s_mov_b32 s76, 262144
Lpoll6:
    buffer_load_dword v125, off, s[32:35], s81 sc1
    s_waitcnt vmcnt(0)
    v_readfirstlane_b32 s77, v125
    s_nop 3
    s_cmp_ge_u32 s77, 32
    s_cbranch_scc1 Lpdone7
    s_sleep 4
    s_sub_u32 s76, s76, 1
    s_cmp_lg_u32 s76, 0
    s_cbranch_scc1 Lpoll6
Lpdone7:
    s_barrier
    s_lshr_b32 s81, s68, 2
    s_xor_b32 s81, s81, 3
    s_lshl_b32 s81, s81, 8
    s_add_u32 s81, s81, s80
    s_mov_b32 s76, 262144
Lpoll8:
    buffer_load_dword v125, off, s[32:35], s81 sc1
    s_waitcnt vmcnt(0)
    v_readfirstlane_b32 s77, v125
    s_nop 3
    s_cmp_ge_u32 s77, 32
    s_cbranch_scc1 Lpdone9
    s_sleep 4
    s_sub_u32 s76, s76, 1
    s_cmp_lg_u32 s76, 0
    s_cbranch_scc1 Lpoll8
Lpdone9:
    s_barrier
    s_lshr_b32 s81, s68, 2
    s_xor_b32 s81, s81, 1
    s_lshl_b32 s81, s81, 8
    s_add_u32 s81, s81, s80
    s_mov_b32 s76, 262144
Lpoll10:
    buffer_load_dword v125, off, s[32:35], s81 sc1
    s_waitcnt vmcnt(0)
    v_readfirstlane_b32 s77, v125
    s_nop 3
    s_cmp_ge_u32 s77, 32
    s_cbranch_scc1 Lpdone11
    s_sleep 4
    s_sub_u32 s76, s76, 1
    s_cmp_lg_u32 s76, 0
    s_cbranch_scc1 Lpoll10
Lpdone11:
    s_barrier
    s_lshr_b32 s81, s68, 2
    s_xor_b32 s81, s81, 0
    s_lshl_b32 s81, s81, 8
    s_add_u32 s81, s81, s80
    s_mov_b32 s76, 262144
Lpoll12:
    buffer_load_dword v125, off, s[32:35], s81 sc1
    s_waitcnt vmcnt(0)
    v_readfirstlane_b32 s77, v125
    s_nop 3
    s_cmp_ge_u32 s77, 32
    s_cbranch_scc1 Lpdone13
    s_sleep 4
    s_sub_u32 s76, s76, 1
    s_cmp_lg_u32 s76, 0
    s_cbranch_scc1 Lpoll12
Lpdone13:
    s_barrier
L_at_x:
    s_endpgm
L_at_ld:
    s_barrier
    s_waitcnt vmcnt(0)
    v_mov_b32 v125, 1
    s_mov_b64 exec, 1
    buffer_atomic_add v125, off, s[32:35], s81
    s_mov_b64 exec, -1
    s_barrier
    s_lshl_b32 s70, s69, 11
    s_add_u32 s70, s70, 0
    v_add_u32 v126, s70, v3
    ds_write_b128 v126, v[136:139] offset:0
    ds_write_b128 v126, v[140:143] offset:1024
    ds_write_b128 v126, v[144:147] offset:8192
    ds_write_b128 v126, v[148:151] offset:9216
    ds_write_b128 v126, v[152:155] offset:16384
    ds_write_b128 v126, v[156:159] offset:17408
    ds_write_b128 v126, v[160:163] offset:24576
    ds_write_b128 v126, v[164:167] offset:25600
    s_waitcnt lgkmcnt(0)
    s_endpgm
L_wget:
    s_lshr_b32 s70, s66, 2
    s_xor_b32 s70, s70, 1
    s_lshr_b32 s71, s68, 2
    s_xor_b32 s71, s71, s70
    s_lshl_b32 s71, s71, 19
    buffer_load_dwordx4 v[136:139], v132, s[28:31], s71 offen offset:0
    buffer_load_dwordx4 v[140:143], v133, s[28:31], s71 offen offset:1024
    s_add_u32 s71, s71, 131072
    buffer_load_dwordx4 v[144:147], v132, s[28:31], s71 offen offset:0
    buffer_load_dwordx4 v[148:151], v133, s[28:31], s71 offen offset:1024
    s_add_u32 s71, s71, 131072
    buffer_load_dwordx4 v[152:155], v132, s[28:31], s71 offen offset:0
    buffer_load_dwordx4 v[156:159], v133, s[28:31], s71 offen offset:1024
    s_add_u32 s71, s71, 131072
    buffer_load_dwordx4 v[160:163], v132, s[28:31], s71 offen offset:0
    buffer_load_dwordx4 v[164:167], v133, s[28:31], s71 offen offset:1024
    s_branch L_wget_b
L_slow:
    s_mov_b64 s[72:73], -1
    v_mov_b32 v125, 0xff800000
    s_mov_b32 s76, 0x0
L_slow_max:
    buffer_load_dwordx4 v[68:71], v3, s[32:35], s76 offen offset:0 sc1
    buffer_load_dwordx4 v[72:75], v3, s[32:35], s76 offen offset:1024 sc1
    s_waitcnt vmcnt(0)
    v_mfma_f32_32x32x16_bf16 v[28:43], v[68:71], v[4:7], 0
    v_mfma_f32_32x32x16_bf16 v[28:43], v[72:75], v[8:11], v[28:43]
    s_nop 15
    v_max3_f32 v126, v28, v29, v30
    v_max3_f32 v126, v126, v31, v32
    v_max3_f32 v126, v126, v33, v34
    v_max3_f32 v126, v126, v35, v36
    v_max3_f32 v126, v126, v37, v38
    v_max3_f32 v126, v126, v39, v40
    v_max3_f32 v126, v126, v41, v42
    v_max_f32 v126, v126, v43
    v_mov_b32 v127, v126
    s_nop 1
    v_permlane32_swap_b32 v126, v127
    s_nop 1
    v_max_f32 v126, v126, v127
    v_max_f32 v125, v125, v126
    s_add_u32 s76, s76, 4096
    s_cmp_lt_u32 s76, 0x40000
    s_cbranch_scc1 L_slow_max
    v_sub_f32 v12, 0, v125
    v_sub_f32 v13, 0, v125
    v_sub_f32 v14, 0, v125
    v_sub_f32 v15, 0, v125
    v_sub_f32 v16, 0, v125
    v_sub_f32 v17, 0, v125
    v_sub_f32 v18, 0, v125
    v_sub_f32 v19, 0, v125
    v_sub_f32 v20, 0, v125
    v_sub_f32 v21, 0, v125
    v_sub_f32 v22, 0, v125
    v_sub_f32 v23, 0, v125
    v_sub_f32 v24, 0, v125
    v_sub_f32 v25, 0, v125
    v_sub_f32 v26, 0, v125
    v_sub_f32 v27, 0, v125
    v_mov_b32 v100, 0
    v_mov_b32 v101, 0
    v_mov_b32 v102, 0
    v_mov_b32 v103, 0
    v_mov_b32 v104, 0
    v_mov_b32 v105, 0
    v_mov_b32 v106, 0
    v_mov_b32 v107, 0
    v_mov_b32 v108, 0
    v_mov_b32 v109, 0
    v_mov_b32 v110, 0
    v_mov_b32 v111, 0
    v_mov_b32 v112, 0
    v_mov_b32 v113, 0
    v_mov_b32 v114, 0
    v_mov_b32 v115, 0
    v_mov_b32 v116, 0
    v_mov_b32 v117, 0
    v_mov_b32 v118, 0
    v_mov_b32 v119, 0
    s_mov_b32 s76, 0
L_slow_pv:
    s_add_u32 s77, s76, 63
    s_and_b32 s77, s77, 63
    s_lshl_b32 s77, s77, 12
    s_add_u32 s77, s77, 0x0
    s_lshl_b32 s78, s76, 12
    s_add_u32 s78, s78, 0x800
    buffer_load_dwordx4 v[68:71], v3, s[32:35], s77 offen offset:0 sc1
    buffer_load_dwordx4 v[72:75], v3, s[32:35], s77 offen offset:1024 sc1
    buffer_load_dwordx4 v[76:79], v3, s[32:35], s78 offen offset:0 sc1
    buffer_load_dwordx4 v[80:83], v3, s[32:35], s78 offen offset:1024 sc1
    s_waitcnt vmcnt(0)
    v_mfma_f32_32x32x16_bf16 v[28:43], v[68:71], v[4:7], v[12:27]
    v_mfma_f32_32x32x16_bf16 v[28:43], v[72:75], v[8:11], v[28:43]
    s_nop 15
    v_exp_f32 v28, v28
    v_exp_f32 v29, v29
    v_exp_f32 v30, v30
    v_exp_f32 v31, v31
    v_exp_f32 v32, v32
    v_exp_f32 v33, v33
    v_exp_f32 v34, v34
    v_exp_f32 v35, v35
    v_exp_f32 v36, v36
    v_exp_f32 v37, v37
    v_exp_f32 v38, v38
    v_exp_f32 v39, v39
    v_exp_f32 v40, v40
    v_exp_f32 v41, v41
    v_exp_f32 v42, v42
    v_exp_f32 v43, v43
    s_nop 0
    v_cvt_pk_bf16_f32 v60, v28, v29
    v_cvt_pk_bf16_f32 v61, v30, v31
    v_cvt_pk_bf16_f32 v62, v32, v33
    v_cvt_pk_bf16_f32 v63, v34, v35
    v_cvt_pk_bf16_f32 v64, v36, v37
    v_cvt_pk_bf16_f32 v65, v38, v39
    v_cvt_pk_bf16_f32 v66, v40, v41
    v_cvt_pk_bf16_f32 v67, v42, v43
    s_nop 1
    v_mfma_f32_32x32x16_bf16 v[100:115], v[76:79], v[60:63], v[100:115]
    v_mfma_f32_32x32x16_bf16 v[100:115], v[80:83], v[64:67], v[100:115]
    v_smfmac_f32_16x16x64_bf16 v[116:119], v[120:123], v[60:67], v1
    s_add_u32 s76, s76, 1
    s_cmp_lt_u32 s76, 64
    s_cbranch_scc1 L_slow_pv
    s_nop 15
    s_branch L_at_fin
L_gm:
    s_setprio 2
    v_and_b32 v96, 31, v0
    v_lshrrev_b32 v97, 5, v0
    v_bfe_u32 v98, v0, 1, 3
    s_lshr_b32 s70, s69, 1
    s_lshl_b32 s70, s70, 13
    s_add_u32 s70, s70, 102400
    v_add_u32 v99, 0, v97
    v_xor_b32 v99, v99, v98
    v_lshlrev_b32 v99, 4, v99
    v_lshl_add_u32 v4, v96, 7, v99
    v_add_u32 v4, s70, v4
    v_add_u32 v99, 2, v97
    v_xor_b32 v99, v99, v98
    v_lshlrev_b32 v99, 4, v99
    v_lshl_add_u32 v5, v96, 7, v99
    v_add_u32 v5, s70, v5
    v_add_u32 v99, 4, v97
    v_xor_b32 v99, v99, v98
    v_lshlrev_b32 v99, 4, v99
    v_lshl_add_u32 v6, v96, 7, v99
    v_add_u32 v6, s70, v6
    v_add_u32 v99, 6, v97
    v_xor_b32 v99, v99, v98
    v_lshlrev_b32 v99, 4, v99
    v_lshl_add_u32 v7, v96, 7, v99
    v_add_u32 v7, s70, v7
    v_bfe_u32 v98, v0, 2, 2
    v_bfe_u32 v99, v0, 4, 1
    v_and_b32 v96, 3, v0
    v_lshlrev_b32 v99, 5, v99
    v_lshl_add_u32 v99, v96, 3, v99
    v_lshrrev_b32 v96, 1, v98
    v_lshl_add_u32 v100, v97, 3, v98
    v_lshl_add_u32 v101, v97, 2, v98
    s_and_b32 s70, s69, 1
    v_xor_b32 v102, s70, v96
    v_lshl_add_u32 v102, v102, 6, v99
    v_lshl_add_u32 v8, v100, 7, v102
    v_add_u32 v8, 102400, v8
    v_lshl_add_u32 v102, v96, 6, v99
    v_lshl_add_u32 v12, v101, 7, v102
    v_xor_b32 v13, 64, v12
    v_lshrrev_b32 v103, 4, v0
    v_bfe_u32 v104, v0, 1, 3
    v_xor_b32 v104, v104, v103
    v_lshlrev_b32 v104, 4, v104
    v_and_b32 v105, 15, v0
    s_lshr_b32 s70, s69, 1
    s_lshl_b32 s70, s70, 13
    s_add_u32 s70, s70, 102400
    v_lshl_add_u32 v1, v105, 7, v104
    v_add_u32 v1, s70, v1
    v_xor_b32 v9, 64, v1
    s_and_b32 s70, s69, 1
    v_xor_b32 v104, s70, v96
    v_lshl_add_u32 v104, v104, 6, v99
    v_lshl_add_u32 v105, v103, 3, v98
    v_lshl_add_u32 v14, v105, 7, v104
    v_add_u32 v14, 102400, v14
    v_xor_b32 v15, 32, v14
    v_and_b32 v103, 32, v0
    v_lshrrev_b32 v104, 1, v103
    v_bfe_u32 v105, v0, 4, 1
    v_lshl_add_u32 v104, v105, 2, v104
    v_add_u32 v104, v104, v98
    v_lshl_add_u32 v12, v104, 7, v102
    v_lshrrev_b32 v100, 3, v0
    s_lshl_b32 s70, s69, 4
    v_add_u32 v100, s70, v100
    s_movk_i32 s70, 2048
    v_mul_lo_u32 v100, v100, s70
    v_bfe_u32 v101, v0, 4, 1
    v_lshlrev_b32 v101, 2, v101
    v_and_b32 v10, 7, v0
    v_xor_b32 v101, v101, v10
    v_lshl_add_u32 v10, v101, 4, v100
    s_lshl_b32 s70, s68, 7
    v_add_u32 v10, s70, v10
    v_add_u32 v11, 15360, v10
    v_xor_b32 v10, v10, v103
    v_xor_b32 v11, v11, v103
    v_mov_b32 v152, 0
    v_mov_b32 v153, 0
    v_mov_b32 v154, 0
    v_mov_b32 v155, 0
    v_mov_b32 v156, 0
    v_mov_b32 v157, 0
    v_mov_b32 v158, 0
    v_mov_b32 v159, 0
    v_mov_b32 v160, 0
    v_mov_b32 v161, 0
    v_mov_b32 v162, 0
    v_mov_b32 v163, 0
    v_mov_b32 v164, 0
    v_mov_b32 v165, 0
    v_mov_b32 v166, 0
    v_mov_b32 v167, 0
    v_mov_b32 v136, 0
    v_mov_b32 v137, 0
    v_mov_b32 v138, 0
    v_mov_b32 v139, 0
    v_mov_b32 v140, 0
    v_mov_b32 v141, 0
    v_mov_b32 v142, 0
    v_mov_b32 v143, 0
    v_mov_b32 v144, 0
    v_mov_b32 v145, 0
    v_mov_b32 v146, 0
    v_mov_b32 v147, 0
    v_mov_b32 v148, 0
    v_mov_b32 v149, 0
    v_mov_b32 v150, 0
    v_mov_b32 v151, 0
    s_mov_b32 s77, 102400
    s_mov_b32 s76, 7
    s_waitcnt lgkmcnt(0)
    s_mov_b32 s32, s64
    s_mov_b32 s33, s65
    s_mov_b32 s34, 0x900000
    s_mov_b32 s35, 0x00020000
    s_mov_b32 s24, s48
    s_mov_b32 s25, s49
    s_mov_b32 s26, 0x200000
    s_mov_b32 s27, 0x00020000
    s_mov_b32 s28, s58
    s_mov_b32 s29, s59
    s_mov_b32 s30, 0x200000
    s_mov_b32 s31, 0x00020000
    s_mov_b32 s36, s60
    s_mov_b32 s37, s61
    s_mov_b32 s38, 0x800000
    s_mov_b32 s39, 0x00020000
    s_mov_b32 s20, s64
    s_mov_b32 s21, s65
    s_mov_b32 s22, 0x900000
    s_mov_b32 s23, 0x00020000
    s_barrier
    s_barrier
    ds_read_b128 v[16:19], v1 offset:0
    ds_read_b64_tr_b16 v[32:33], v14 offset:16384
    ds_read_b64_tr_b16 v[34:35], v14 offset:16896
    ds_read_b64_tr_b16 v[36:37], v15 offset:16384
    ds_read_b64_tr_b16 v[38:39], v15 offset:16896
    ds_read_b128 v[20:23], v1 offset:2048
    ds_read_b128 v[24:27], v1 offset:4096
    ds_read_b128 v[28:31], v1 offset:6144
    ds_read_b128 v[40:43], v9 offset:0
    ds_read_b64_tr_b16 v[56:57], v14 offset:20480
    ds_read_b64_tr_b16 v[58:59], v14 offset:20992
    ds_read_b64_tr_b16 v[60:61], v15 offset:20480
    ds_read_b64_tr_b16 v[62:63], v15 offset:20992
    ds_read_b128 v[44:47], v9 offset:2048
    ds_read_b128 v[48:51], v9 offset:4096
    ds_read_b128 v[52:55], v9 offset:6144
    s_mov_b32 s78, 40960
    s_mov_b32 s79, 40960
    s_bitcmp1_b32 s76, 0
    s_cselect_b32 s78, 0xfffe7000, s78
    s_cselect_b32 s79, 0x6000, s79
    v_add_u32 v1, s78, v1
    v_add_u32 v9, s78, v9
    v_add_u32 v14, s79, v14
    v_add_u32 v15, s79, v15
.p2align 6
L_gb:
    s_waitcnt lgkmcnt(0)
    v_mfma_f32_16x16x32_bf16 v[136:139], v[32:35], v[16:19], v[136:139]
    v_mfma_f32_16x16x32_bf16 v[140:143], v[36:39], v[16:19], v[140:143]
    s_barrier
    v_mfma_f32_16x16x32_bf16 v[144:147], v[32:35], v[20:23], v[144:147]
    ds_read_b128 v[64:67], v1 offset:0
    ds_read_b64_tr_b16 v[80:81], v14 offset:16384
    v_mfma_f32_16x16x32_bf16 v[148:151], v[36:39], v[20:23], v[148:151]
    ds_read_b64_tr_b16 v[82:83], v14 offset:16896
    ds_read_b64_tr_b16 v[84:85], v15 offset:16384
    v_mfma_f32_16x16x32_bf16 v[152:155], v[32:35], v[24:27], v[152:155]
    ds_read_b64_tr_b16 v[86:87], v15 offset:16896
    ds_read_b128 v[68:71], v1 offset:2048
    v_mfma_f32_16x16x32_bf16 v[156:159], v[36:39], v[24:27], v[156:159]
    ds_read_b128 v[72:75], v1 offset:4096
    ds_read_b128 v[76:79], v1 offset:6144
    v_mfma_f32_16x16x32_bf16 v[160:163], v[32:35], v[28:31], v[160:163]
    ds_read_b128 v[88:91], v9 offset:0
    ds_read_b64_tr_b16 v[104:105], v14 offset:20480
    v_mfma_f32_16x16x32_bf16 v[164:167], v[36:39], v[28:31], v[164:167]
    ds_read_b64_tr_b16 v[106:107], v14 offset:20992
    ds_read_b64_tr_b16 v[108:109], v15 offset:20480
    v_mfma_f32_16x16x32_bf16 v[136:139], v[56:59], v[40:43], v[136:139]
    ds_read_b64_tr_b16 v[110:111], v15 offset:20992
    ds_read_b128 v[92:95], v9 offset:2048
    v_mfma_f32_16x16x32_bf16 v[140:143], v[60:63], v[40:43], v[140:143]
    ds_read_b128 v[96:99], v9 offset:4096
    ds_read_b128 v[100:103], v9 offset:6144
    v_mfma_f32_16x16x32_bf16 v[144:147], v[56:59], v[44:47], v[144:147]
    s_mov_b32 s78, 40960
    s_mov_b32 s79, 40960
    s_bitcmp1_b32 s76, 0
    s_cselect_b32 s78, 0x5000, s78
    s_cselect_b32 s79, 0xfffe6000, s79
    v_mfma_f32_16x16x32_bf16 v[148:151], v[60:63], v[44:47], v[148:151]
    v_add_u32 v1, s78, v1
    v_mfma_f32_16x16x32_bf16 v[152:155], v[56:59], v[48:51], v[152:155]
    v_add_u32 v9, s78, v9
    v_mfma_f32_16x16x32_bf16 v[156:159], v[60:63], v[48:51], v[156:159]
    v_add_u32 v14, s79, v14
    v_mfma_f32_16x16x32_bf16 v[160:163], v[56:59], v[52:55], v[160:163]
    v_add_u32 v15, s79, v15
    v_mfma_f32_16x16x32_bf16 v[164:167], v[60:63], v[52:55], v[164:167]
    s_waitcnt lgkmcnt(0)
    v_mfma_f32_16x16x32_bf16 v[136:139], v[80:83], v[64:67], v[136:139]
    v_mfma_f32_16x16x32_bf16 v[140:143], v[84:87], v[64:67], v[140:143]
    s_barrier
    v_mfma_f32_16x16x32_bf16 v[144:147], v[80:83], v[68:71], v[144:147]
    ds_read_b128 v[16:19], v1 offset:0
    ds_read_b64_tr_b16 v[32:33], v14 offset:16384
    v_mfma_f32_16x16x32_bf16 v[148:151], v[84:87], v[68:71], v[148:151]
    ds_read_b64_tr_b16 v[34:35], v14 offset:16896
    ds_read_b64_tr_b16 v[36:37], v15 offset:16384
    v_mfma_f32_16x16x32_bf16 v[152:155], v[80:83], v[72:75], v[152:155]
    ds_read_b64_tr_b16 v[38:39], v15 offset:16896
    ds_read_b128 v[20:23], v1 offset:2048
    v_mfma_f32_16x16x32_bf16 v[156:159], v[84:87], v[72:75], v[156:159]
    ds_read_b128 v[24:27], v1 offset:4096
    ds_read_b128 v[28:31], v1 offset:6144
    v_mfma_f32_16x16x32_bf16 v[160:163], v[80:83], v[76:79], v[160:163]
    ds_read_b128 v[40:43], v9 offset:0
    ds_read_b64_tr_b16 v[56:57], v14 offset:20480
    v_mfma_f32_16x16x32_bf16 v[164:167], v[84:87], v[76:79], v[164:167]
    ds_read_b64_tr_b16 v[58:59], v14 offset:20992
    ds_read_b64_tr_b16 v[60:61], v15 offset:20480
    v_mfma_f32_16x16x32_bf16 v[136:139], v[104:107], v[88:91], v[136:139]
    ds_read_b64_tr_b16 v[62:63], v15 offset:20992
    ds_read_b128 v[44:47], v9 offset:2048
    v_mfma_f32_16x16x32_bf16 v[140:143], v[108:111], v[88:91], v[140:143]
    ds_read_b128 v[48:51], v9 offset:4096
    ds_read_b128 v[52:55], v9 offset:6144
    v_mfma_f32_16x16x32_bf16 v[144:147], v[104:107], v[92:95], v[144:147]
    s_mov_b32 s78, 40960
    s_mov_b32 s79, 40960
    s_bitcmp0_b32 s76, 0
    s_cselect_b32 s78, 0xfffe7000, s78
    s_cselect_b32 s79, 0x6000, s79
    v_mfma_f32_16x16x32_bf16 v[148:151], v[108:111], v[92:95], v[148:151]
    v_add_u32 v1, s78, v1
    v_mfma_f32_16x16x32_bf16 v[152:155], v[104:107], v[96:99], v[152:155]
    v_add_u32 v9, s78, v9
    v_mfma_f32_16x16x32_bf16 v[156:159], v[108:111], v[96:99], v[156:159]
    v_add_u32 v14, s79, v14
    v_mfma_f32_16x16x32_bf16 v[160:163], v[104:107], v[100:103], v[160:163]
    v_add_u32 v15, s79, v15
    v_mfma_f32_16x16x32_bf16 v[164:167], v[108:111], v[100:103], v[164:167]
    s_sub_u32 s76, s76, 1
    s_cmp_lg_u32 s76, 0
    s_cbranch_scc1 L_gb
    s_waitcnt lgkmcnt(0)
    v_mfma_f32_16x16x32_bf16 v[136:139], v[32:35], v[16:19], v[136:139]
    v_mfma_f32_16x16x32_bf16 v[140:143], v[36:39], v[16:19], v[140:143]
    s_barrier
    v_mfma_f32_16x16x32_bf16 v[144:147], v[32:35], v[20:23], v[144:147]
    ds_read_b128 v[64:67], v1 offset:0
    ds_read_b64_tr_b16 v[80:81], v14 offset:16384
    v_mfma_f32_16x16x32_bf16 v[148:151], v[36:39], v[20:23], v[148:151]
    ds_read_b64_tr_b16 v[82:83], v14 offset:16896
    ds_read_b64_tr_b16 v[84:85], v15 offset:16384
    v_mfma_f32_16x16x32_bf16 v[152:155], v[32:35], v[24:27], v[152:155]
    ds_read_b64_tr_b16 v[86:87], v15 offset:16896
    ds_read_b128 v[68:71], v1 offset:2048
    v_mfma_f32_16x16x32_bf16 v[156:159], v[36:39], v[24:27], v[156:159]
    ds_read_b128 v[72:75], v1 offset:4096
    ds_read_b128 v[76:79], v1 offset:6144
    v_mfma_f32_16x16x32_bf16 v[160:163], v[32:35], v[28:31], v[160:163]
    ds_read_b128 v[88:91], v9 offset:0
    ds_read_b64_tr_b16 v[104:105], v14 offset:20480
    v_mfma_f32_16x16x32_bf16 v[164:167], v[36:39], v[28:31], v[164:167]
    ds_read_b64_tr_b16 v[106:107], v14 offset:20992
    ds_read_b64_tr_b16 v[108:109], v15 offset:20480
    v_mfma_f32_16x16x32_bf16 v[136:139], v[56:59], v[40:43], v[136:139]
    ds_read_b64_tr_b16 v[110:111], v15 offset:20992
    ds_read_b128 v[92:95], v9 offset:2048
    v_mfma_f32_16x16x32_bf16 v[140:143], v[60:63], v[40:43], v[140:143]
    ds_read_b128 v[96:99], v9 offset:4096
    ds_read_b128 v[100:103], v9 offset:6144
    v_mfma_f32_16x16x32_bf16 v[144:147], v[56:59], v[44:47], v[144:147]
    s_mov_b32 s78, 40960
    s_mov_b32 s79, 40960
    s_bitcmp1_b32 s76, 0
    s_cselect_b32 s78, 0x5000, s78
    s_cselect_b32 s79, 0xfffe6000, s79
    v_mfma_f32_16x16x32_bf16 v[148:151], v[60:63], v[44:47], v[148:151]
    v_add_u32 v1, s78, v1
    v_mfma_f32_16x16x32_bf16 v[152:155], v[56:59], v[48:51], v[152:155]
    v_add_u32 v9, s78, v9
    v_mfma_f32_16x16x32_bf16 v[156:159], v[60:63], v[48:51], v[156:159]
    v_add_u32 v14, s79, v14
    v_mfma_f32_16x16x32_bf16 v[160:163], v[56:59], v[52:55], v[160:163]
    v_add_u32 v15, s79, v15
    v_mfma_f32_16x16x32_bf16 v[164:167], v[60:63], v[52:55], v[164:167]
    s_waitcnt lgkmcnt(0)
    v_mfma_f32_16x16x32_bf16 v[136:139], v[80:83], v[64:67], v[136:139]
    v_mfma_f32_16x16x32_bf16 v[140:143], v[84:87], v[64:67], v[140:143]
    s_barrier
    v_mfma_f32_16x16x32_bf16 v[144:147], v[80:83], v[68:71], v[144:147]
    ds_read_b128 v[16:19], v1 offset:0
    ds_read_b64_tr_b16 v[48:49], v14 offset:16384
    v_mfma_f32_16x16x32_bf16 v[148:151], v[84:87], v[68:71], v[148:151]
    ds_read_b64_tr_b16 v[50:51], v14 offset:16896
    ds_read_b64_tr_b16 v[52:53], v15 offset:16384
    v_mfma_f32_16x16x32_bf16 v[152:155], v[80:83], v[72:75], v[152:155]
    ds_read_b64_tr_b16 v[54:55], v15 offset:16896
    ds_read_b128 v[20:23], v1 offset:2048
    v_mfma_f32_16x16x32_bf16 v[156:159], v[84:87], v[72:75], v[156:159]
    ds_read_b128 v[24:27], v1 offset:4096
    ds_read_b128 v[28:31], v1 offset:6144
    v_mfma_f32_16x16x32_bf16 v[160:163], v[80:83], v[76:79], v[160:163]
    ds_read_b64_tr_b16 v[56:57], v14 offset:24576
    ds_read_b64_tr_b16 v[58:59], v14 offset:25088
    v_mfma_f32_16x16x32_bf16 v[164:167], v[84:87], v[76:79], v[164:167]
    ds_read_b64_tr_b16 v[60:61], v15 offset:24576
    ds_read_b64_tr_b16 v[62:63], v15 offset:25088
    v_mfma_f32_16x16x32_bf16 v[136:139], v[104:107], v[88:91], v[136:139]
    v_mfma_f32_16x16x32_bf16 v[140:143], v[108:111], v[88:91], v[140:143]
    v_mfma_f32_16x16x32_bf16 v[144:147], v[104:107], v[92:95], v[144:147]
    v_mfma_f32_16x16x32_bf16 v[148:151], v[108:111], v[92:95], v[148:151]
    v_mfma_f32_16x16x32_bf16 v[152:155], v[104:107], v[96:99], v[152:155]
    v_mfma_f32_16x16x32_bf16 v[156:159], v[108:111], v[96:99], v[156:159]
    v_mfma_f32_16x16x32_bf16 v[160:163], v[104:107], v[100:103], v[160:163]
    v_mfma_f32_16x16x32_bf16 v[164:167], v[108:111], v[100:103], v[164:167]
    s_lshr_b32 s70, s69, 1
    s_lshl_b32 s70, s70, 13
    s_and_b32 s71, s69, 1
    s_lshl_b32 s71, s71, 11
    s_add_u32 s70, s70, s71
    s_add_u32 s70, s70, 143360
    v_add_u32 v4, s70, v3
    v_lshrrev_b32 v5, 4, v0
    v_and_b32 v4, 15, v0
    v_lshlrev_b32 v4, 4, v4
    v_lshl_add_u32 v4, v5, 9, v4
    v_add_u32 v4, s70, v4
    s_waitcnt lgkmcnt(4)
    v_mfma_f32_16x16x32_bf16 v[72:75], v[48:51], v[16:19], 0
    ds_read_b64_tr_b16 v[64:65], v14 offset:32768
    ds_read_b64_tr_b16 v[66:67], v14 offset:33280
    v_mfma_f32_16x16x32_bf16 v[76:79], v[52:55], v[16:19], 0
    ds_read_b64_tr_b16 v[68:69], v15 offset:32768
    ds_read_b64_tr_b16 v[70:71], v15 offset:33280
    v_mfma_f32_16x16x32_bf16 v[80:83], v[48:51], v[20:23], 0
    v_cvt_pk_bf16_f32 v136, v136, v137
    v_cvt_pk_bf16_f32 v137, v138, v139
    v_cvt_pk_bf16_f32 v138, v140, v141
    v_cvt_pk_bf16_f32 v139, v142, v143
    v_mfma_f32_16x16x32_bf16 v[84:87], v[52:55], v[20:23], 0
    v_cvt_pk_bf16_f32 v140, v144, v145
    v_cvt_pk_bf16_f32 v141, v146, v147
    v_cvt_pk_bf16_f32 v142, v148, v149
    v_cvt_pk_bf16_f32 v143, v150, v151
    v_mfma_f32_16x16x32_bf16 v[88:91], v[48:51], v[24:27], 0
    v_cvt_pk_bf16_f32 v144, v152, v153
    v_cvt_pk_bf16_f32 v145, v154, v155
    v_cvt_pk_bf16_f32 v146, v156, v157
    v_mfma_f32_16x16x32_bf16 v[92:95], v[52:55], v[24:27], 0
    v_cvt_pk_bf16_f32 v147, v158, v159
    v_cvt_pk_bf16_f32 v148, v160, v161
    v_cvt_pk_bf16_f32 v149, v162, v163
    v_mfma_f32_16x16x32_bf16 v[96:99], v[48:51], v[28:31], 0
    v_cvt_pk_bf16_f32 v150, v164, v165
    v_cvt_pk_bf16_f32 v151, v166, v167
    ds_write_b128 v4, v[136:139] offset:0
    v_mfma_f32_16x16x32_bf16 v[100:103], v[52:55], v[28:31], 0
    ds_write_b128 v4, v[140:143] offset:256
    ds_write_b128 v4, v[144:147] offset:4096
    ds_write_b128 v4, v[148:151] offset:4352
    s_waitcnt lgkmcnt(8)
    v_mfma_f32_16x16x32_bf16 v[104:107], v[16:19], v[56:59], 0
    ds_read_b128 v[32:35], v9 offset:0
    v_mfma_f32_16x16x32_bf16 v[112:115], v[16:19], v[60:63], 0
    ds_read_b64_tr_b16 v[48:49], v14 offset:20480
    v_mfma_f32_16x16x32_bf16 v[108:111], v[20:23], v[56:59], 0
    ds_read_b64_tr_b16 v[50:51], v14 offset:20992
    v_mfma_f32_16x16x32_bf16 v[116:119], v[20:23], v[60:63], 0
    ds_read_b64_tr_b16 v[52:53], v15 offset:20480
    v_mfma_f32_16x16x32_bf16 v[120:123], v[24:27], v[56:59], 0
    ds_read_b64_tr_b16 v[54:55], v15 offset:20992
    v_mfma_f32_16x16x32_bf16 v[128:131], v[24:27], v[60:63], 0
    ds_read_b128 v[36:39], v9 offset:2048
    v_mfma_f32_16x16x32_bf16 v[124:127], v[28:31], v[56:59], 0
    ds_read_b128 v[40:43], v9 offset:4096
    v_mfma_f32_16x16x32_bf16 v[132:135], v[28:31], v[60:63], 0
    ds_read_b128 v[44:47], v9 offset:6144
    s_waitcnt lgkmcnt(8)
    v_mfma_f32_16x16x32_bf16 v[136:139], v[16:19], v[64:67], 0
    ds_read_b64_tr_b16 v[56:57], v14 offset:28672
    v_mfma_f32_16x16x32_bf16 v[144:147], v[16:19], v[68:71], 0
    ds_read_b64_tr_b16 v[58:59], v14 offset:29184
    v_mfma_f32_16x16x32_bf16 v[140:143], v[20:23], v[64:67], 0
    ds_read_b64_tr_b16 v[60:61], v15 offset:28672
    v_mfma_f32_16x16x32_bf16 v[148:151], v[20:23], v[68:71], 0
    ds_read_b64_tr_b16 v[62:63], v15 offset:29184
    v_mfma_f32_16x16x32_bf16 v[152:155], v[24:27], v[64:67], 0
    v_mfma_f32_16x16x32_bf16 v[160:163], v[24:27], v[68:71], 0
    v_mfma_f32_16x16x32_bf16 v[156:159], v[28:31], v[64:67], 0
    v_mfma_f32_16x16x32_bf16 v[164:167], v[28:31], v[68:71], 0
    s_waitcnt lgkmcnt(4)
    v_mfma_f32_16x16x32_bf16 v[72:75], v[48:51], v[32:35], v[72:75]
    ds_read_b64_tr_b16 v[64:65], v14 offset:36864
    v_mfma_f32_16x16x32_bf16 v[76:79], v[52:55], v[32:35], v[76:79]
    ds_read_b64_tr_b16 v[66:67], v14 offset:37376
    v_mfma_f32_16x16x32_bf16 v[80:83], v[48:51], v[36:39], v[80:83]
    ds_read_b64_tr_b16 v[68:69], v15 offset:36864
    v_mfma_f32_16x16x32_bf16 v[84:87], v[52:55], v[36:39], v[84:87]
    ds_read_b64_tr_b16 v[70:71], v15 offset:37376
    v_mfma_f32_16x16x32_bf16 v[88:91], v[48:51], v[40:43], v[88:91]
    s_mov_b32 s78, s77
    s_add_u32 s77, s77, 40960
    s_cmp_ge_u32 s77, 143360
    s_cselect_b32 s77, 20480, s77
    s_sub_u32 s78, s77, s78
    v_add_u32 v1, s78, v1
    v_mfma_f32_16x16x32_bf16 v[92:95], v[52:55], v[40:43], v[92:95]
    v_add_u32 v9, s78, v9
    v_mfma_f32_16x16x32_bf16 v[96:99], v[48:51], v[44:47], v[96:99]
    v_add_u32 v14, s78, v14
    v_mfma_f32_16x16x32_bf16 v[100:103], v[52:55], v[44:47], v[100:103]
    v_add_u32 v15, s78, v15
    s_waitcnt lgkmcnt(4)
    v_mfma_f32_16x16x32_bf16 v[104:107], v[32:35], v[56:59], v[104:107]
    v_mfma_f32_16x16x32_bf16 v[112:115], v[32:35], v[60:63], v[112:115]
    s_waitcnt lgkmcnt(0)
    s_barrier
    v_mfma_f32_16x16x32_bf16 v[108:111], v[36:39], v[56:59], v[108:111]
    ds_read_b128 v[16:19], v1 offset:0
    ds_read_b64_tr_b16 v[48:49], v14 offset:16384
    v_mfma_f32_16x16x32_bf16 v[116:119], v[36:39], v[60:63], v[116:119]
    ds_read_b64_tr_b16 v[50:51], v14 offset:16896
    ds_read_b64_tr_b16 v[52:53], v15 offset:16384
    v_mfma_f32_16x16x32_bf16 v[120:123], v[40:43], v[56:59], v[120:123]
    ds_read_b64_tr_b16 v[54:55], v15 offset:16896
    v_mfma_f32_16x16x32_bf16 v[128:131], v[40:43], v[60:63], v[128:131]
    ds_read_b128 v[20:23], v1 offset:2048
    v_mfma_f32_16x16x32_bf16 v[124:127], v[44:47], v[56:59], v[124:127]
    ds_read_b128 v[24:27], v1 offset:4096
    v_mfma_f32_16x16x32_bf16 v[132:135], v[44:47], v[60:63], v[132:135]
    ds_read_b128 v[28:31], v1 offset:6144
    s_waitcnt lgkmcnt(8)
    v_mfma_f32_16x16x32_bf16 v[136:139], v[32:35], v[64:67], v[136:139]
    ds_read_b64_tr_b16 v[56:57], v14 offset:24576
    v_mfma_f32_16x16x32_bf16 v[144:147], v[32:35], v[68:71], v[144:147]
    ds_read_b64_tr_b16 v[58:59], v14 offset:25088
    v_mfma_f32_16x16x32_bf16 v[140:143], v[36:39], v[64:67], v[140:143]
    ds_read_b64_tr_b16 v[60:61], v15 offset:24576
    v_mfma_f32_16x16x32_bf16 v[148:151], v[36:39], v[68:71], v[148:151]
    ds_read_b64_tr_b16 v[62:63], v15 offset:25088
    v_mfma_f32_16x16x32_bf16 v[152:155], v[40:43], v[64:67], v[152:155]
    v_mfma_f32_16x16x32_bf16 v[160:163], v[40:43], v[68:71], v[160:163]
    v_mfma_f32_16x16x32_bf16 v[156:159], v[44:47], v[64:67], v[156:159]
    v_mfma_f32_16x16x32_bf16 v[164:167], v[44:47], v[68:71], v[164:167]
    s_mov_b32 s76, 15
.p2align 6
L_ga:
    s_waitcnt lgkmcnt(4)
    v_mfma_f32_16x16x32_bf16 v[72:75], v[48:51], v[16:19], v[72:75]
    ds_read_b64_tr_b16 v[64:65], v14 offset:32768
    v_mfma_f32_16x16x32_bf16 v[76:79], v[52:55], v[16:19], v[76:79]
    ds_read_b64_tr_b16 v[66:67], v14 offset:33280
    v_mfma_f32_16x16x32_bf16 v[80:83], v[48:51], v[20:23], v[80:83]
    ds_read_b64_tr_b16 v[68:69], v15 offset:32768
    v_mfma_f32_16x16x32_bf16 v[84:87], v[52:55], v[20:23], v[84:87]
    ds_read_b64_tr_b16 v[70:71], v15 offset:33280
    v_mfma_f32_16x16x32_bf16 v[88:91], v[48:51], v[24:27], v[88:91]
    v_mfma_f32_16x16x32_bf16 v[92:95], v[52:55], v[24:27], v[92:95]
    v_mfma_f32_16x16x32_bf16 v[96:99], v[48:51], v[28:31], v[96:99]
    v_mfma_f32_16x16x32_bf16 v[100:103], v[52:55], v[28:31], v[100:103]
    s_waitcnt lgkmcnt(4)
    v_mfma_f32_16x16x32_bf16 v[104:107], v[16:19], v[56:59], v[104:107]
    ds_read_b128 v[32:35], v9 offset:0
    v_mfma_f32_16x16x32_bf16 v[112:115], v[16:19], v[60:63], v[112:115]
    ds_read_b64_tr_b16 v[48:49], v14 offset:20480
    v_mfma_f32_16x16x32_bf16 v[108:111], v[20:23], v[56:59], v[108:111]
    ds_read_b64_tr_b16 v[50:51], v14 offset:20992
    v_mfma_f32_16x16x32_bf16 v[116:119], v[20:23], v[60:63], v[116:119]
    ds_read_b64_tr_b16 v[52:53], v15 offset:20480
    v_mfma_f32_16x16x32_bf16 v[120:123], v[24:27], v[56:59], v[120:123]
    ds_read_b64_tr_b16 v[54:55], v15 offset:20992
    v_mfma_f32_16x16x32_bf16 v[128:131], v[24:27], v[60:63], v[128:131]
    ds_read_b128 v[36:39], v9 offset:2048
    v_mfma_f32_16x16x32_bf16 v[124:127], v[28:31], v[56:59], v[124:127]
    ds_read_b128 v[40:43], v9 offset:4096
    v_mfma_f32_16x16x32_bf16 v[132:135], v[28:31], v[60:63], v[132:135]
    ds_read_b128 v[44:47], v9 offset:6144
    s_waitcnt lgkmcnt(8)
    v_mfma_f32_16x16x32_bf16 v[136:139], v[16:19], v[64:67], v[136:139]
    ds_read_b64_tr_b16 v[56:57], v14 offset:28672
    v_mfma_f32_16x16x32_bf16 v[144:147], v[16:19], v[68:71], v[144:147]
    ds_read_b64_tr_b16 v[58:59], v14 offset:29184
    v_mfma_f32_16x16x32_bf16 v[140:143], v[20:23], v[64:67], v[140:143]
    ds_read_b64_tr_b16 v[60:61], v15 offset:28672
    v_mfma_f32_16x16x32_bf16 v[148:151], v[20:23], v[68:71], v[148:151]
    ds_read_b64_tr_b16 v[62:63], v15 offset:29184
    v_mfma_f32_16x16x32_bf16 v[152:155], v[24:27], v[64:67], v[152:155]
    v_mfma_f32_16x16x32_bf16 v[160:163], v[24:27], v[68:71], v[160:163]
    v_mfma_f32_16x16x32_bf16 v[156:159], v[28:31], v[64:67], v[156:159]
    v_mfma_f32_16x16x32_bf16 v[164:167], v[28:31], v[68:71], v[164:167]
    s_waitcnt lgkmcnt(4)
    v_mfma_f32_16x16x32_bf16 v[72:75], v[48:51], v[32:35], v[72:75]
    ds_read_b64_tr_b16 v[64:65], v14 offset:36864
    v_mfma_f32_16x16x32_bf16 v[76:79], v[52:55], v[32:35], v[76:79]
    ds_read_b64_tr_b16 v[66:67], v14 offset:37376
    v_mfma_f32_16x16x32_bf16 v[80:83], v[48:51], v[36:39], v[80:83]
    ds_read_b64_tr_b16 v[68:69], v15 offset:36864
    v_mfma_f32_16x16x32_bf16 v[84:87], v[52:55], v[36:39], v[84:87]
    ds_read_b64_tr_b16 v[70:71], v15 offset:37376
    v_mfma_f32_16x16x32_bf16 v[88:91], v[48:51], v[40:43], v[88:91]
    s_mov_b32 s78, s77
    s_add_u32 s77, s77, 40960
    s_cmp_ge_u32 s77, 143360
    s_cselect_b32 s77, 20480, s77
    s_sub_u32 s78, s77, s78
    v_add_u32 v1, s78, v1
    v_mfma_f32_16x16x32_bf16 v[92:95], v[52:55], v[40:43], v[92:95]
    v_add_u32 v9, s78, v9
    v_mfma_f32_16x16x32_bf16 v[96:99], v[48:51], v[44:47], v[96:99]
    v_add_u32 v14, s78, v14
    v_mfma_f32_16x16x32_bf16 v[100:103], v[52:55], v[44:47], v[100:103]
    v_add_u32 v15, s78, v15
    s_waitcnt lgkmcnt(4)
    v_mfma_f32_16x16x32_bf16 v[104:107], v[32:35], v[56:59], v[104:107]
    v_mfma_f32_16x16x32_bf16 v[112:115], v[32:35], v[60:63], v[112:115]
    s_waitcnt lgkmcnt(0)
    s_barrier
    v_mfma_f32_16x16x32_bf16 v[108:111], v[36:39], v[56:59], v[108:111]
    ds_read_b128 v[16:19], v1 offset:0
    ds_read_b64_tr_b16 v[48:49], v14 offset:16384
    v_mfma_f32_16x16x32_bf16 v[116:119], v[36:39], v[60:63], v[116:119]
    ds_read_b64_tr_b16 v[50:51], v14 offset:16896
    ds_read_b64_tr_b16 v[52:53], v15 offset:16384
    v_mfma_f32_16x16x32_bf16 v[120:123], v[40:43], v[56:59], v[120:123]
    ds_read_b64_tr_b16 v[54:55], v15 offset:16896
    v_mfma_f32_16x16x32_bf16 v[128:131], v[40:43], v[60:63], v[128:131]
    ds_read_b128 v[20:23], v1 offset:2048
    v_mfma_f32_16x16x32_bf16 v[124:127], v[44:47], v[56:59], v[124:127]
    ds_read_b128 v[24:27], v1 offset:4096
    v_mfma_f32_16x16x32_bf16 v[132:135], v[44:47], v[60:63], v[132:135]
    ds_read_b128 v[28:31], v1 offset:6144
    s_waitcnt lgkmcnt(8)
    v_mfma_f32_16x16x32_bf16 v[136:139], v[32:35], v[64:67], v[136:139]
    ds_read_b64_tr_b16 v[56:57], v14 offset:24576
    v_mfma_f32_16x16x32_bf16 v[144:147], v[32:35], v[68:71], v[144:147]
    ds_read_b64_tr_b16 v[58:59], v14 offset:25088
    v_mfma_f32_16x16x32_bf16 v[140:143], v[36:39], v[64:67], v[140:143]
    ds_read_b64_tr_b16 v[60:61], v15 offset:24576
    v_mfma_f32_16x16x32_bf16 v[148:151], v[36:39], v[68:71], v[148:151]
    ds_read_b64_tr_b16 v[62:63], v15 offset:25088
    v_mfma_f32_16x16x32_bf16 v[152:155], v[40:43], v[64:67], v[152:155]
    s_sub_u32 s76, s76, 1
    s_cmp_lg_u32 s76, 0
    v_mfma_f32_16x16x32_bf16 v[160:163], v[40:43], v[68:71], v[160:163]
    v_mfma_f32_16x16x32_bf16 v[156:159], v[44:47], v[64:67], v[156:159]
    v_mfma_f32_16x16x32_bf16 v[164:167], v[44:47], v[68:71], v[164:167]
    s_cbranch_scc1 L_ga
    s_mov_b32 s70, 0x3fb8aa3b
    s_mov_b32 s71, 0x3fb8aa3b
    s_mov_b32 s72, 0x358637bd
    s_lshl_b32 s73, s68, 1
    s_and_b32 s74, s69, 1
    s_add_u32 s73, s73, s74
    s_lshl_b32 s74, s73, 12
    s_add_u32 s74, s74, 0x40000
    s_lshl_b32 s75, s73, 7
    s_add_u32 s75, s75, 0x60000
    s_mul_i32 s76, s68, 1152
    s_add_u32 s76, s76, 0x62000
    v_mov_b32 v14, 151552
    v_mov_b32 v15, 0
    ds_write_b32 v14, v15
    s_waitcnt lgkmcnt(0)
    v_mov_b32 v64, 0x3f803f80
    v_mov_b32 v65, 0x3f803f80
    v_mov_b32 v66, 0x3f803f80
    v_mov_b32 v67, 0x3f803f80
    v_pk_mul_f32 v[48:49], v[104:105], s[70:71]
    v_pk_mul_f32 v[50:51], v[106:107], s[70:71]
    v_pk_mul_f32 v[52:53], v[108:109], s[70:71]
    v_pk_mul_f32 v[54:55], v[110:111], s[70:71]
    v_pk_mul_f32 v[56:57], v[112:113], s[70:71]
    v_pk_mul_f32 v[58:59], v[114:115], s[70:71]
    v_pk_mul_f32 v[60:61], v[116:117], s[70:71]
    v_pk_mul_f32 v[62:63], v[118:119], s[70:71]
    v_exp_f32_e64 v48, v48 clamp
    v_max_f32_e32 v104, s72, v104
    v_exp_f32_e64 v49, v49 clamp
    v_max_f32_e32 v105, s72, v105
    v_exp_f32_e64 v50, v50 clamp
    v_max_f32_e32 v106, s72, v106
    v_exp_f32_e64 v51, v51 clamp
    v_max_f32_e32 v107, s72, v107
    v_exp_f32_e64 v52, v52 clamp
    v_max_f32_e32 v108, s72, v108
    v_exp_f32_e64 v53, v53 clamp
    v_max_f32_e32 v109, s72, v109
    v_exp_f32_e64 v54, v54 clamp
    v_max_f32_e32 v110, s72, v110
    v_exp_f32_e64 v55, v55 clamp
    v_max_f32_e32 v111, s72, v111
    v_exp_f32_e64 v56, v56 clamp
    v_max_f32_e32 v112, s72, v112
    v_exp_f32_e64 v57, v57 clamp
    v_max_f32_e32 v113, s72, v113
    v_exp_f32_e64 v58, v58 clamp
    v_max_f32_e32 v114, s72, v114
    v_exp_f32_e64 v59, v59 clamp
    v_max_f32_e32 v115, s72, v115
    v_exp_f32_e64 v60, v60 clamp
    v_max_f32_e32 v116, s72, v116
    v_exp_f32_e64 v61, v61 clamp
    v_max_f32_e32 v117, s72, v117
    v_exp_f32_e64 v62, v62 clamp
    v_max_f32_e32 v118, s72, v118
    v_exp_f32_e64 v63, v63 clamp
    v_max_f32_e32 v119, s72, v119
    v_pk_add_f32 v[104:105], v[104:105], v[48:49]
    v_pk_add_f32 v[106:107], v[106:107], v[50:51]
    v_pk_add_f32 v[108:109], v[108:109], v[52:53]
    v_pk_add_f32 v[110:111], v[110:111], v[54:55]
    v_pk_add_f32 v[112:113], v[112:113], v[56:57]
    v_pk_add_f32 v[114:115], v[114:115], v[58:59]
    v_pk_add_f32 v[116:117], v[116:117], v[60:61]
    v_pk_add_f32 v[118:119], v[118:119], v[62:63]
    v_cvt_pk_bf16_f32 v16, v104, v105
    v_cvt_pk_bf16_f32 v17, v106, v107
    v_cvt_pk_bf16_f32 v18, v108, v109
    v_cvt_pk_bf16_f32 v19, v110, v111
    v_cvt_pk_bf16_f32 v20, v112, v113
    v_cvt_pk_bf16_f32 v21, v114, v115
    v_cvt_pk_bf16_f32 v22, v116, v117
    v_cvt_pk_bf16_f32 v23, v118, v119
    v_cvt_pk_bf16_f32 v32, v136, v137
    v_cvt_pk_bf16_f32 v33, v138, v139
    v_cvt_pk_bf16_f32 v34, v140, v141
    v_cvt_pk_bf16_f32 v35, v142, v143
    v_cvt_pk_bf16_f32 v36, v144, v145
    v_cvt_pk_bf16_f32 v37, v146, v147
    v_cvt_pk_bf16_f32 v38, v148, v149
    v_cvt_pk_bf16_f32 v39, v150, v151
    v_pk_mul_f32 v[48:49], v[120:121], s[70:71]
    v_pk_mul_f32 v[50:51], v[122:123], s[70:71]
    v_pk_mul_f32 v[52:53], v[124:125], s[70:71]
    v_pk_mul_f32 v[54:55], v[126:127], s[70:71]
    v_pk_mul_f32 v[56:57], v[128:129], s[70:71]
    v_pk_mul_f32 v[58:59], v[130:131], s[70:71]
    v_pk_mul_f32 v[60:61], v[132:133], s[70:71]
    v_pk_mul_f32 v[62:63], v[134:135], s[70:71]
    v_exp_f32_e64 v48, v48 clamp
    v_max_f32_e32 v120, s72, v120
    v_exp_f32_e64 v49, v49 clamp
    v_max_f32_e32 v121, s72, v121
    v_exp_f32_e64 v50, v50 clamp
    v_max_f32_e32 v122, s72, v122
    v_exp_f32_e64 v51, v51 clamp
    v_max_f32_e32 v123, s72, v123
    v_exp_f32_e64 v52, v52 clamp
    v_max_f32_e32 v124, s72, v124
    v_exp_f32_e64 v53, v53 clamp
    v_max_f32_e32 v125, s72, v125
    v_exp_f32_e64 v54, v54 clamp
    v_max_f32_e32 v126, s72, v126
    v_exp_f32_e64 v55, v55 clamp
    v_max_f32_e32 v127, s72, v127
    v_exp_f32_e64 v56, v56 clamp
    v_max_f32_e32 v128, s72, v128
    v_exp_f32_e64 v57, v57 clamp
    v_max_f32_e32 v129, s72, v129
    v_exp_f32_e64 v58, v58 clamp
    v_max_f32_e32 v130, s72, v130
    v_exp_f32_e64 v59, v59 clamp
    v_max_f32_e32 v131, s72, v131
    v_exp_f32_e64 v60, v60 clamp
    v_max_f32_e32 v132, s72, v132
    v_exp_f32_e64 v61, v61 clamp
    v_max_f32_e32 v133, s72, v133
    v_exp_f32_e64 v62, v62 clamp
    v_max_f32_e32 v134, s72, v134
    v_exp_f32_e64 v63, v63 clamp
    v_max_f32_e32 v135, s72, v135
    v_pk_add_f32 v[120:121], v[120:121], v[48:49]
    v_pk_add_f32 v[122:123], v[122:123], v[50:51]
    v_pk_add_f32 v[124:125], v[124:125], v[52:53]
    v_pk_add_f32 v[126:127], v[126:127], v[54:55]
    v_pk_add_f32 v[128:129], v[128:129], v[56:57]
    v_pk_add_f32 v[130:131], v[130:131], v[58:59]
    v_pk_add_f32 v[132:133], v[132:133], v[60:61]
    v_pk_add_f32 v[134:135], v[134:135], v[62:63]
    v_cvt_pk_bf16_f32 v24, v120, v121
    v_cvt_pk_bf16_f32 v25, v122, v123
    v_cvt_pk_bf16_f32 v26, v124, v125
    v_cvt_pk_bf16_f32 v27, v126, v127
    v_cvt_pk_bf16_f32 v28, v128, v129
    v_cvt_pk_bf16_f32 v29, v130, v131
    v_cvt_pk_bf16_f32 v30, v132, v133
    v_cvt_pk_bf16_f32 v31, v134, v135
    v_cvt_pk_bf16_f32 v40, v152, v153
    v_cvt_pk_bf16_f32 v41, v154, v155
    v_cvt_pk_bf16_f32 v42, v156, v157
    v_cvt_pk_bf16_f32 v43, v158, v159
    v_cvt_pk_bf16_f32 v44, v160, v161
    v_cvt_pk_bf16_f32 v45, v162, v163
    v_cvt_pk_bf16_f32 v46, v164, v165
    v_cvt_pk_bf16_f32 v47, v166, v167
    v_lshlrev_b32 v14, 2, v0
    v_and_b32 v15, 16, v0
    v_cmp_eq_u32 vcc, 0, v15
    v_mfma_f32_16x16x32_bf16 v[104:107], v[16:19], v[32:35], 0
    v_mfma_f32_16x16x32_bf16 v[112:115], v[16:19], v[36:39], 0
    v_mfma_f32_16x16x32_bf16 v[120:123], v[64:67], v[16:19], 0
    v_mfma_f32_16x16x32_bf16 v[108:111], v[20:23], v[32:35], 0
    v_mfma_f32_16x16x32_bf16 v[116:119], v[20:23], v[36:39], 0
    v_mfma_f32_16x16x32_bf16 v[124:127], v[64:67], v[20:23], 0
    v_mfma_f32_16x16x32_bf16 v[104:107], v[24:27], v[40:43], v[104:107]
    v_mfma_f32_16x16x32_bf16 v[112:115], v[24:27], v[44:47], v[112:115]
    v_mfma_f32_16x16x32_bf16 v[120:123], v[64:67], v[24:27], v[120:123]
    v_mfma_f32_16x16x32_bf16 v[108:111], v[28:31], v[40:43], v[108:111]
    v_mfma_f32_16x16x32_bf16 v[116:119], v[28:31], v[44:47], v[116:119]
    v_mfma_f32_16x16x32_bf16 v[124:127], v[64:67], v[28:31], v[124:127]
    v_pk_mul_f32 v[152:153], v[72:73], s[70:71]
    v_pk_mul_f32 v[154:155], v[74:75], s[70:71]
    v_pk_mul_f32 v[156:157], v[76:77], s[70:71]
    v_pk_mul_f32 v[158:159], v[78:79], s[70:71]
    v_pk_mul_f32 v[160:161], v[80:81], s[70:71]
    v_pk_mul_f32 v[162:163], v[82:83], s[70:71]
    v_pk_mul_f32 v[164:165], v[84:85], s[70:71]
    v_pk_mul_f32 v[166:167], v[86:87], s[70:71]
    v_exp_f32_e64 v152, v152 clamp
    v_max_f32_e32 v72, s72, v72
    v_exp_f32_e64 v153, v153 clamp
    v_max_f32_e32 v73, s72, v73
    v_exp_f32_e64 v154, v154 clamp
    v_max_f32_e32 v74, s72, v74
    v_exp_f32_e64 v155, v155 clamp
    v_max_f32_e32 v75, s72, v75
    v_exp_f32_e64 v156, v156 clamp
    v_max_f32_e32 v76, s72, v76
    v_exp_f32_e64 v157, v157 clamp
    v_max_f32_e32 v77, s72, v77
    v_exp_f32_e64 v158, v158 clamp
    v_max_f32_e32 v78, s72, v78
    v_exp_f32_e64 v159, v159 clamp
    v_max_f32_e32 v79, s72, v79
    v_exp_f32_e64 v160, v160 clamp
    v_max_f32_e32 v80, s72, v80
    v_exp_f32_e64 v161, v161 clamp
    v_max_f32_e32 v81, s72, v81
    v_exp_f32_e64 v162, v162 clamp
    v_max_f32_e32 v82, s72, v82
    v_exp_f32_e64 v163, v163 clamp
    v_max_f32_e32 v83, s72, v83
    v_exp_f32_e64 v164, v164 clamp
    v_max_f32_e32 v84, s72, v84
    v_exp_f32_e64 v165, v165 clamp
    v_max_f32_e32 v85, s72, v85
    v_exp_f32_e64 v166, v166 clamp
    v_max_f32_e32 v86, s72, v86
    v_exp_f32_e64 v167, v167 clamp
    v_max_f32_e32 v87, s72, v87
    v_pk_add_f32 v[72:73], v[72:73], v[152:153]
    v_pk_add_f32 v[74:75], v[74:75], v[154:155]
    v_pk_add_f32 v[76:77], v[76:77], v[156:157]
    v_pk_add_f32 v[78:79], v[78:79], v[158:159]
    v_pk_add_f32 v[80:81], v[80:81], v[160:161]
    v_pk_add_f32 v[82:83], v[82:83], v[162:163]
    v_pk_add_f32 v[84:85], v[84:85], v[164:165]
    v_pk_add_f32 v[86:87], v[86:87], v[166:167]
    v_cvt_pk_bf16_f32 v136, v72, v73
    v_cvt_pk_bf16_f32 v137, v74, v75
    v_cvt_pk_bf16_f32 v138, v76, v77
    v_cvt_pk_bf16_f32 v139, v78, v79
    v_cvt_pk_bf16_f32 v140, v80, v81
    v_cvt_pk_bf16_f32 v141, v82, v83
    v_cvt_pk_bf16_f32 v142, v84, v85
    v_cvt_pk_bf16_f32 v143, v86, v87
    v_cndmask_b32 v120, v124, v120, vcc
    buffer_atomic_add_f32 v104, v14, s[32:35], s74 offen offset:0
    buffer_atomic_add_f32 v105, v14, s[32:35], s74 offen offset:256
    buffer_atomic_add_f32 v106, v14, s[32:35], s74 offen offset:512
    buffer_atomic_add_f32 v107, v14, s[32:35], s74 offen offset:768
    buffer_atomic_add_f32 v108, v14, s[32:35], s74 offen offset:1024
    buffer_atomic_add_f32 v109, v14, s[32:35], s74 offen offset:1280
    buffer_atomic_add_f32 v110, v14, s[32:35], s74 offen offset:1536
    buffer_atomic_add_f32 v111, v14, s[32:35], s74 offen offset:1792
    buffer_atomic_add_f32 v112, v14, s[32:35], s74 offen offset:2048
    buffer_atomic_add_f32 v113, v14, s[32:35], s74 offen offset:2304
    buffer_atomic_add_f32 v114, v14, s[32:35], s74 offen offset:2560
    buffer_atomic_add_f32 v115, v14, s[32:35], s74 offen offset:2816
    buffer_atomic_add_f32 v116, v14, s[32:35], s74 offen offset:3072
    buffer_atomic_add_f32 v117, v14, s[32:35], s74 offen offset:3328
    buffer_atomic_add_f32 v118, v14, s[32:35], s74 offen offset:3584
    buffer_atomic_add_f32 v119, v14, s[32:35], s74 offen offset:3840
    s_mov_b32 exec_hi, 0
    buffer_atomic_add_f32 v120, v14, s[32:35], s75 offen
    s_mov_b64 exec, -1
    v_pk_mul_f32 v[152:153], v[88:89], s[70:71]
    v_pk_mul_f32 v[154:155], v[90:91], s[70:71]
    v_pk_mul_f32 v[156:157], v[92:93], s[70:71]
    v_pk_mul_f32 v[158:159], v[94:95], s[70:71]
    v_pk_mul_f32 v[160:161], v[96:97], s[70:71]
    v_pk_mul_f32 v[162:163], v[98:99], s[70:71]
    v_pk_mul_f32 v[164:165], v[100:101], s[70:71]
    v_pk_mul_f32 v[166:167], v[102:103], s[70:71]
    v_exp_f32_e64 v152, v152 clamp
    v_max_f32_e32 v88, s72, v88
    v_exp_f32_e64 v153, v153 clamp
    v_max_f32_e32 v89, s72, v89
    v_exp_f32_e64 v154, v154 clamp
    v_max_f32_e32 v90, s72, v90
    v_exp_f32_e64 v155, v155 clamp
    v_max_f32_e32 v91, s72, v91
    v_exp_f32_e64 v156, v156 clamp
    v_max_f32_e32 v92, s72, v92
    v_exp_f32_e64 v157, v157 clamp
    v_max_f32_e32 v93, s72, v93
    v_exp_f32_e64 v158, v158 clamp
    v_max_f32_e32 v94, s72, v94
    v_exp_f32_e64 v159, v159 clamp
    v_max_f32_e32 v95, s72, v95
    v_exp_f32_e64 v160, v160 clamp
    v_max_f32_e32 v96, s72, v96
    v_exp_f32_e64 v161, v161 clamp
    v_max_f32_e32 v97, s72, v97
    v_exp_f32_e64 v162, v162 clamp
    v_max_f32_e32 v98, s72, v98
    v_exp_f32_e64 v163, v163 clamp
    v_max_f32_e32 v99, s72, v99
    v_exp_f32_e64 v164, v164 clamp
    v_max_f32_e32 v100, s72, v100
    v_exp_f32_e64 v165, v165 clamp
    v_max_f32_e32 v101, s72, v101
    v_exp_f32_e64 v166, v166 clamp
    v_max_f32_e32 v102, s72, v102
    v_exp_f32_e64 v167, v167 clamp
    v_max_f32_e32 v103, s72, v103
    v_pk_add_f32 v[88:89], v[88:89], v[152:153]
    v_pk_add_f32 v[90:91], v[90:91], v[154:155]
    v_pk_add_f32 v[92:93], v[92:93], v[156:157]
    v_pk_add_f32 v[94:95], v[94:95], v[158:159]
    v_pk_add_f32 v[96:97], v[96:97], v[160:161]
    v_pk_add_f32 v[98:99], v[98:99], v[162:163]
    v_pk_add_f32 v[100:101], v[100:101], v[164:165]
    v_pk_add_f32 v[102:103], v[102:103], v[166:167]
    v_cvt_pk_bf16_f32 v144, v88, v89
    v_cvt_pk_bf16_f32 v145, v90, v91
    v_cvt_pk_bf16_f32 v146, v92, v93
    v_cvt_pk_bf16_f32 v147, v94, v95
    v_cvt_pk_bf16_f32 v148, v96, v97
    v_cvt_pk_bf16_f32 v149, v98, v99
    v_cvt_pk_bf16_f32 v150, v100, v101
    v_cvt_pk_bf16_f32 v151, v102, v103
    s_barrier
    s_waitcnt vmcnt(0)
    v_mov_b32 v18, 1
    v_mov_b32 v19, 151552
    s_mov_b64 exec, 1
    ds_add_rtn_u32 v19, v19, v18
    s_waitcnt lgkmcnt(0)
    v_readfirstlane_b32 s78, v19
    s_nop 3
    s_cmp_lg_u32 s78, 3
    s_cbranch_scc1 Larr14
    buffer_atomic_add v18, off, s[32:35], s76
Larr14:
    s_mov_b64 exec, -1
    s_cmp_lg_u32 s69, 0
    s_cbranch_scc1 Lnp15
    s_mov_b32 s78, 262144
Lpoll16:
    buffer_load_dword v15, off, s[32:35], s76 sc1
    s_waitcnt vmcnt(0)
    v_readfirstlane_b32 s79, v15
    s_nop 3
    s_cmp_ge_u32 s79, 16
    s_cbranch_scc1 Lpdone17
    s_sleep 4
    s_sub_u32 s78, s78, 1
    s_cmp_lg_u32 s78, 0
    s_cbranch_scc1 Lpoll16
Lpdone17:
Lnp15:
    s_and_b32 s82, s67, 3
    s_lshl_b32 s82, s82, 2
    s_add_u32 s82, s82, s69
    s_lshl_b32 s82, s82, 17
    s_lshl_b32 s83, s68, 7
    s_add_u32 s82, s82, s83
    v_lshlrev_b32 v16, 11, v0
    buffer_load_dword v17, v16, s[24:27], s82 offen
    buffer_load_dword v17, v16, s[28:31], s82 offen
    s_barrier
    s_lshl_b32 s80, s69, 10
    s_add_u32 s81, s80, 0x0
    buffer_load_dword v16, v14, s[32:35], s74 offen offset:0 sc1
    buffer_load_dword v17, v14, s[32:35], s74 offen offset:256 sc1
    buffer_load_dword v18, v14, s[32:35], s74 offen offset:512 sc1
    buffer_load_dword v19, v14, s[32:35], s74 offen offset:768 sc1
    buffer_load_dword v20, v14, s[32:35], s74 offen offset:1024 sc1
    buffer_load_dword v21, v14, s[32:35], s74 offen offset:1280 sc1
    buffer_load_dword v22, v14, s[32:35], s74 offen offset:1536 sc1
    buffer_load_dword v23, v14, s[32:35], s74 offen offset:1792 sc1
    buffer_load_dword v24, v14, s[32:35], s74 offen offset:2048 sc1
    buffer_load_dword v25, v14, s[32:35], s74 offen offset:2304 sc1
    buffer_load_dword v26, v14, s[32:35], s74 offen offset:2560 sc1
    buffer_load_dword v27, v14, s[32:35], s74 offen offset:2816 sc1
    buffer_load_dword v28, v14, s[32:35], s74 offen offset:3072 sc1
    buffer_load_dword v29, v14, s[32:35], s74 offen offset:3328 sc1
    buffer_load_dword v30, v14, s[32:35], s74 offen offset:3584 sc1
    buffer_load_dword v31, v14, s[32:35], s74 offen offset:3840 sc1
    v_and_b32 v15, 48, v0
    buffer_load_dwordx4 v[32:35], v15, s[32:35], s75 offen offset:0 sc1
    buffer_load_dwordx4 v[36:39], v15, s[32:35], s75 offen offset:64 sc1
    s_add_u32 m0, s80, 143360
    s_add_u32 s82, s81, 147456
    buffer_load_dwordx4 v3, s[32:35], s82 offen sc1 lds
    s_add_u32 m0, s80, 147456
    s_add_u32 s82, s81, 151552
    buffer_load_dwordx4 v3, s[32:35], s82 offen sc1 lds
    s_add_u32 m0, s80, 151552
    s_add_u32 s82, s81, 155648
    buffer_load_dwordx4 v3, s[32:35], s82 offen sc1 lds
    s_add_u32 m0, s80, 155648
    s_add_u32 s82, s81, 159744
    buffer_load_dwordx4 v3, s[32:35], s82 offen sc1 lds
    s_add_u32 m0, s80, 159744
    s_add_u32 s82, s81, 163840
    buffer_load_dwordx4 v3, s[32:35], s82 offen sc1 lds
    s_add_u32 m0, s80, 0
    s_add_u32 s82, s81, 167936
    buffer_load_dwordx4 v3, s[32:35], s82 offen sc1 lds
    s_add_u32 m0, s80, 4096
    s_add_u32 s82, s81, 172032
    buffer_load_dwordx4 v3, s[32:35], s82 offen sc1 lds
    s_add_u32 m0, s80, 8192
    s_add_u32 s82, s81, 176128
    buffer_load_dwordx4 v3, s[32:35], s82 offen sc1 lds
    s_add_u32 m0, s80, 12288
    s_add_u32 s82, s81, 180224
    buffer_load_dwordx4 v3, s[32:35], s82 offen sc1 lds
    s_add_u32 m0, s80, 16384
    s_add_u32 s82, s81, 184320
    buffer_load_dwordx4 v3, s[32:35], s82 offen sc1 lds
    s_add_u32 m0, s80, 20480
    s_add_u32 s82, s81, 188416
    buffer_load_dwordx4 v3, s[32:35], s82 offen sc1 lds
    s_add_u32 m0, s80, 24576
    s_add_u32 s82, s81, 192512
    buffer_load_dwordx4 v3, s[32:35], s82 offen sc1 lds
    s_add_u32 m0, s80, 28672
    s_add_u32 s82, s81, 196608
    buffer_load_dwordx4 v3, s[32:35], s82 offen sc1 lds
    s_add_u32 m0, s80, 32768
    s_add_u32 s82, s81, 200704
    buffer_load_dwordx4 v3, s[32:35], s82 offen sc1 lds
    s_add_u32 m0, s80, 36864
    s_add_u32 s82, s81, 204800
    buffer_load_dwordx4 v3, s[32:35], s82 offen sc1 lds
    s_add_u32 m0, s80, 40960
    s_add_u32 s82, s81, 208896
    buffer_load_dwordx4 v3, s[32:35], s82 offen sc1 lds
    s_add_u32 m0, s80, 45056
    s_add_u32 s82, s81, 212992
    buffer_load_dwordx4 v3, s[32:35], s82 offen sc1 lds
    s_add_u32 m0, s80, 49152
    s_add_u32 s82, s81, 217088
    buffer_load_dwordx4 v3, s[32:35], s82 offen sc1 lds
    s_add_u32 m0, s80, 53248
    s_add_u32 s82, s81, 221184
    buffer_load_dwordx4 v3, s[32:35], s82 offen sc1 lds
    s_add_u32 m0, s80, 57344
    s_add_u32 s82, s81, 225280
    buffer_load_dwordx4 v3, s[32:35], s82 offen sc1 lds
    s_add_u32 m0, s80, 61440
    s_add_u32 s82, s81, 229376
    buffer_load_dwordx4 v3, s[32:35], s82 offen sc1 lds
    s_add_u32 m0, s80, 65536
    s_add_u32 s82, s81, 233472
    buffer_load_dwordx4 v3, s[32:35], s82 offen sc1 lds
    s_add_u32 m0, s80, 69632
    s_add_u32 s82, s81, 237568
    buffer_load_dwordx4 v3, s[32:35], s82 offen sc1 lds
    s_add_u32 m0, s80, 73728
    s_add_u32 s82, s81, 241664
    buffer_load_dwordx4 v3, s[32:35], s82 offen sc1 lds
    s_add_u32 m0, s80, 77824
    s_add_u32 s82, s81, 245760
    buffer_load_dwordx4 v3, s[32:35], s82 offen sc1 lds
    s_add_u32 m0, s80, 81920
    s_add_u32 s82, s81, 249856
    buffer_load_dwordx4 v3, s[32:35], s82 offen sc1 lds
    s_add_u32 m0, s80, 86016
    s_add_u32 s82, s81, 253952
    buffer_load_dwordx4 v3, s[32:35], s82 offen sc1 lds
    s_add_u32 m0, s80, 90112
    s_add_u32 s82, s81, 258048
    buffer_load_dwordx4 v3, s[32:35], s82 offen sc1 lds
    s_lshl_b32 s82, s67, 5
    s_add_u32 s82, s82, s73
    s_lshl_b32 s82, s82, 2
    s_and_b32 s83, s69, 2
    s_add_u32 s82, s82, s83
    s_lshl_b32 s82, s82, 11
    s_add_u32 s82, s82, 0x100000
    s_mul_i32 s83, s67, 1152
    s_add_u32 s73, s83, 0x6e000
    s_add_u32 s83, s83, 0x68000
    v_mov_b32 v96, 97280
    v_mov_b32 v98, 0
    v_mov_b32 v99, 0
    ds_write_b64 v96, v[98:99]
    s_waitcnt vmcnt(28)
    v_cvt_pk_bf16_f32 v48, v16, v17
    v_cvt_pk_bf16_f32 v49, v18, v19
    v_cvt_pk_bf16_f32 v50, v20, v21
    v_cvt_pk_bf16_f32 v51, v22, v23
    v_cvt_pk_bf16_f32 v52, v24, v25
    v_cvt_pk_bf16_f32 v53, v26, v27
    v_cvt_pk_bf16_f32 v54, v28, v29
    v_cvt_pk_bf16_f32 v55, v30, v31
    v_cvt_pk_bf16_f32 v56, v32, v33
    v_cvt_pk_bf16_f32 v57, v34, v35
    v_cvt_pk_bf16_f32 v58, v36, v37
    v_cvt_pk_bf16_f32 v59, v38, v39
    v_lshrrev_b32 v15, 4, v0
    v_and_b32 v14, 15, v0
    v_lshlrev_b32 v14, 4, v14
    v_lshl_add_u32 v15, v15, 9, v14
    v_mfma_f32_16x16x32_bf16 v[100:103], v[56:59], v[136:139], 0
    v_mfma_f32_16x16x32_bf16 v[64:67], v[48:51], v[136:139], 0
    v_mfma_f32_16x16x32_bf16 v[68:71], v[52:55], v[136:139], 0
    v_mfma_f32_16x16x32_bf16 v[104:107], v[56:59], v[140:143], 0
    v_mfma_f32_16x16x32_bf16 v[72:75], v[48:51], v[140:143], 0
    v_mfma_f32_16x16x32_bf16 v[76:79], v[52:55], v[140:143], 0
    v_mfma_f32_16x16x32_bf16 v[108:111], v[56:59], v[144:147], 0
    v_mfma_f32_16x16x32_bf16 v[80:83], v[48:51], v[144:147], 0
    v_mfma_f32_16x16x32_bf16 v[84:87], v[52:55], v[144:147], 0
    v_mfma_f32_16x16x32_bf16 v[112:115], v[56:59], v[148:151], 0
    v_mfma_f32_16x16x32_bf16 v[88:91], v[48:51], v[148:151], 0
    v_mfma_f32_16x16x32_bf16 v[92:95], v[52:55], v[148:151], 0
    s_and_b32 s70, s69, 1
    s_lshl_b32 s70, s70, 14
    v_subrev_u32 v164, s70, v10
    v_add_u32 v165, 31744, v164
    s_nop 3
    v_add_f32 v100, s72, v100
    v_add_f32 v104, s72, v104
    v_add_f32 v108, s72, v108
    v_add_f32 v112, s72, v112
    v_rcp_f32 v100, v100
    v_rcp_f32 v104, v104
    v_rcp_f32 v108, v108
    v_rcp_f32 v112, v112
    v_mov_b32 v101, v100
    v_mov_b32 v105, v104
    v_mov_b32 v109, v108
    v_mov_b32 v113, v112
    v_pk_mul_f32 v[64:65], v[64:65], v[100:101]
    v_pk_mul_f32 v[66:67], v[66:67], v[100:101]
    v_pk_mul_f32 v[68:69], v[68:69], v[100:101]
    v_pk_mul_f32 v[70:71], v[70:71], v[100:101]
    v_cvt_pk_bf16_f32 v16, v64, v65
    v_cvt_pk_bf16_f32 v17, v66, v67
    v_cvt_pk_bf16_f32 v18, v68, v69
    v_cvt_pk_bf16_f32 v19, v70, v71
    buffer_store_dwordx4 v[16:19], v15, s[32:35], s82 offen offset:0 sc1
    v_pk_mul_f32 v[72:73], v[72:73], v[104:105]
    v_pk_mul_f32 v[74:75], v[74:75], v[104:105]
    v_pk_mul_f32 v[76:77], v[76:77], v[104:105]
    v_pk_mul_f32 v[78:79], v[78:79], v[104:105]
    v_cvt_pk_bf16_f32 v20, v72, v73
    v_cvt_pk_bf16_f32 v21, v74, v75
    v_cvt_pk_bf16_f32 v22, v76, v77
    v_cvt_pk_bf16_f32 v23, v78, v79
    buffer_store_dwordx4 v[20:23], v15, s[32:35], s82 offen offset:256 sc1
    v_pk_mul_f32 v[80:81], v[80:81], v[108:109]
    v_pk_mul_f32 v[82:83], v[82:83], v[108:109]
    v_pk_mul_f32 v[84:85], v[84:85], v[108:109]
    v_pk_mul_f32 v[86:87], v[86:87], v[108:109]
    v_cvt_pk_bf16_f32 v24, v80, v81
    v_cvt_pk_bf16_f32 v25, v82, v83
    v_cvt_pk_bf16_f32 v26, v84, v85
    v_cvt_pk_bf16_f32 v27, v86, v87
    buffer_store_dwordx4 v[24:27], v15, s[32:35], s82 offen offset:2048 sc1
    v_pk_mul_f32 v[88:89], v[88:89], v[112:113]
    v_pk_mul_f32 v[90:91], v[90:91], v[112:113]
    v_pk_mul_f32 v[92:93], v[92:93], v[112:113]
    v_pk_mul_f32 v[94:95], v[94:95], v[112:113]
    v_cvt_pk_bf16_f32 v28, v88, v89
    v_cvt_pk_bf16_f32 v29, v90, v91
    v_cvt_pk_bf16_f32 v30, v92, v93
    v_cvt_pk_bf16_f32 v31, v94, v95
    buffer_store_dwordx4 v[28:31], v15, s[32:35], s82 offen offset:2304 sc1
    s_waitcnt vmcnt(4) lgkmcnt(0)
    s_barrier
    s_waitcnt vmcnt(0)
    v_mov_b32 v14, 1
    v_mov_b32 v15, 97280
    s_mov_b64 exec, 1
    ds_add_rtn_u32 v15, v15, v14
    s_waitcnt lgkmcnt(0)
    v_readfirstlane_b32 s78, v15
    s_nop 3
    s_cmp_lg_u32 s78, 3
    s_cbranch_scc1 Larr18
    buffer_atomic_add v14, off, s[32:35], s83
Larr18:
    s_mov_b64 exec, -1
    s_barrier
    s_lshl_b32 s70, s69, 11
    s_lshr_b32 s71, s68, 2
    s_xor_b32 s71, s71, 2
    s_lshl_b32 s71, s71, 19
    s_add_u32 m0, s70, 98304
    s_nop 0
    buffer_load_dwordx4 v164, s[24:27], s71 offen offset:0  lds
    buffer_load_dwordx4 v165, s[24:27], s71 offen offset:1024  lds
    s_add_u32 m0, s70, 106496
    s_add_u32 s71, s71, 131072
    buffer_load_dwordx4 v164, s[24:27], s71 offen offset:0  lds
    buffer_load_dwordx4 v165, s[24:27], s71 offen offset:1024  lds
    s_add_u32 m0, s70, 114688
    s_add_u32 s71, s71, 131072
    buffer_load_dwordx4 v164, s[24:27], s71 offen offset:0  lds
    buffer_load_dwordx4 v165, s[24:27], s71 offen offset:1024  lds
    s_add_u32 m0, s70, 122880
    s_add_u32 s71, s71, 131072
    buffer_load_dwordx4 v164, s[24:27], s71 offen offset:0  lds
    buffer_load_dwordx4 v165, s[24:27], s71 offen offset:1024  lds
    s_lshl_b32 s70, s69, 11
    s_lshr_b32 s71, s68, 2
    s_xor_b32 s71, s71, 3
    s_lshl_b32 s71, s71, 19
    s_add_u32 m0, s70, 131072
    s_nop 0
    buffer_load_dwordx4 v164, s[24:27], s71 offen offset:0  lds
    buffer_load_dwordx4 v165, s[24:27], s71 offen offset:1024  lds
    s_add_u32 m0, s70, 139264
    s_add_u32 s71, s71, 131072
    buffer_load_dwordx4 v164, s[24:27], s71 offen offset:0  lds
    buffer_load_dwordx4 v165, s[24:27], s71 offen offset:1024  lds
    s_add_u32 m0, s70, 147456
    s_add_u32 s71, s71, 131072
    buffer_load_dwordx4 v164, s[24:27], s71 offen offset:0  lds
    buffer_load_dwordx4 v165, s[24:27], s71 offen offset:1024  lds
    s_add_u32 m0, s70, 155648
    s_add_u32 s71, s71, 131072
    buffer_load_dwordx4 v164, s[24:27], s71 offen offset:0  lds
    buffer_load_dwordx4 v165, s[24:27], s71 offen offset:1024  lds
    s_cmp_lg_u32 s69, 0
    s_cbranch_scc1 Lnp19
    s_mov_b32 s78, 262144
Lpoll20:
    buffer_load_dword v15, off, s[32:35], s83 sc1
    s_waitcnt vmcnt(0)
    v_readfirstlane_b32 s79, v15
    s_nop 3
    s_cmp_ge_u32 s79, 16
    s_cbranch_scc1 Lpdone21
    s_sleep 4
    s_sub_u32 s78, s78, 1
    s_cmp_lg_u32 s78, 0
    s_cbranch_scc1 Lpoll20
Lpdone21:
Lnp19:
    s_waitcnt vmcnt(0)
    s_barrier
    s_lshl_b32 s70, s69, 11
    s_lshr_b32 s71, s68, 2
    s_xor_b32 s71, s71, 1
    s_lshl_b32 s71, s71, 19
    s_add_u32 m0, s70, 0
    s_nop 0
    buffer_load_dwordx4 v164, s[24:27], s71 offen offset:0  lds
    buffer_load_dwordx4 v165, s[24:27], s71 offen offset:1024  lds
    s_add_u32 m0, s70, 8192
    s_add_u32 s71, s71, 131072
    buffer_load_dwordx4 v164, s[24:27], s71 offen offset:0  lds
    buffer_load_dwordx4 v165, s[24:27], s71 offen offset:1024  lds
    s_add_u32 m0, s70, 16384
    s_add_u32 s71, s71, 131072
    buffer_load_dwordx4 v164, s[24:27], s71 offen offset:0  lds
    buffer_load_dwordx4 v165, s[24:27], s71 offen offset:1024  lds
    s_add_u32 m0, s70, 24576
    s_add_u32 s71, s71, 131072
    buffer_load_dwordx4 v164, s[24:27], s71 offen offset:0  lds
    buffer_load_dwordx4 v165, s[24:27], s71 offen offset:1024  lds
    v_lshrrev_b32 v160, 4, v0
    v_and_b32 v3, 15, v0
    v_lshlrev_b32 v3, 4, v3
    v_lshl_add_u32 v3, v160, 9, v3
    s_lshl_b32 s77, s67, 18
    s_lshl_b32 s75, s69, 11
    s_add_u32 s77, s77, s75
    s_lshr_b32 s76, s68, 2
    s_lshl_b32 s76, s76, 16
    s_xor_b32 s74, s76, 131072
    s_add_u32 s74, s74, s77
    s_add_u32 s74, s74, 0x100000
    s_add_u32 s75, s74, 0
    buffer_load_dwordx4 v[48:51], v3, s[20:23], s75 offen offset:0 sc1
    s_add_u32 s75, s74, 0
    buffer_load_dwordx4 v[52:55], v3, s[20:23], s75 offen offset:256 sc1
    s_add_u32 s75, s74, 8192
    buffer_load_dwordx4 v[56:59], v3, s[20:23], s75 offen offset:0 sc1
    s_add_u32 s75, s74, 8192
    buffer_load_dwordx4 v[60:63], v3, s[20:23], s75 offen offset:256 sc1
    s_add_u32 s75, s74, 16384
    buffer_load_dwordx4 v[64:67], v3, s[20:23], s75 offen offset:0 sc1
    s_add_u32 s75, s74, 16384
    buffer_load_dwordx4 v[68:71], v3, s[20:23], s75 offen offset:256 sc1
    s_add_u32 s75, s74, 24576
    buffer_load_dwordx4 v[72:75], v3, s[20:23], s75 offen offset:0 sc1
    s_add_u32 s75, s74, 24576
    buffer_load_dwordx4 v[76:79], v3, s[20:23], s75 offen offset:256 sc1
    s_add_u32 s75, s74, 32768
    buffer_load_dwordx4 v[80:83], v3, s[20:23], s75 offen offset:0 sc1
    s_add_u32 s75, s74, 32768
    buffer_load_dwordx4 v[84:87], v3, s[20:23], s75 offen offset:256 sc1
    s_add_u32 s75, s74, 40960
    buffer_load_dwordx4 v[88:91], v3, s[20:23], s75 offen offset:0 sc1
    s_add_u32 s75, s74, 40960
    buffer_load_dwordx4 v[92:95], v3, s[20:23], s75 offen offset:256 sc1
    s_add_u32 s75, s74, 49152
    buffer_load_dwordx4 v[96:99], v3, s[20:23], s75 offen offset:0 sc1
    s_add_u32 s75, s74, 49152
    buffer_load_dwordx4 v[100:103], v3, s[20:23], s75 offen offset:256 sc1
    s_add_u32 s75, s74, 57344
    buffer_load_dwordx4 v[104:107], v3, s[20:23], s75 offen offset:0 sc1
    s_add_u32 s75, s74, 57344
    buffer_load_dwordx4 v[108:111], v3, s[20:23], s75 offen offset:256 sc1
    v_add_u32 v8, 98304, v12
    v_xor_b32 v9, 32, v8
    v_xor_b32 v1, 64, v8
    v_xor_b32 v13, 96, v8
    ds_read_b64_tr_b16 v[16:17], v8 offset:0
    ds_read_b64_tr_b16 v[18:19], v8 offset:1024
    ds_read_b64_tr_b16 v[20:21], v9 offset:0
    ds_read_b64_tr_b16 v[22:23], v9 offset:1024
    ds_read_b64_tr_b16 v[24:25], v1 offset:0
    ds_read_b64_tr_b16 v[26:27], v1 offset:1024
    ds_read_b64_tr_b16 v[28:29], v13 offset:0
    ds_read_b64_tr_b16 v[30:31], v13 offset:1024
    s_lshl_b32 s70, s69, 12
    s_add_u32 s70, s70, 32768
    v_lshrrev_b32 v15, 3, v0
    v_and_b32 v160, 7, v0
    v_xor_b32 v14, v160, v15
    v_lshlrev_b32 v14, 4, v14
    v_lshl_add_u32 v14, v15, 7, v14
    v_add_u32 v14, s70, v14
    v_lshlrev_b32 v15, 12, v15
    v_lshl_add_u32 v15, v160, 4, v15
    v_and_b32 v161, 15, v0
    v_lshlrev_b32 v161, 7, v161
    v_add_u32 v161, s70, v161
    v_bfe_u32 v162, v0, 4, 1
    v_lshl_add_u32 v161, v162, 3, v161
    v_lshrrev_b32 v162, 5, v0
    v_xor_b32 v162, v162, v160
    v_lshl_add_u32 v4, v162, 4, v161
    v_xor_b32 v5, 32, v4
    v_xor_b32 v6, 64, v4
    v_xor_b32 v7, 96, v4
    s_setprio 0
    s_mov_b32 s79, 131072
    s_xor_b32 s74, s76, 196608
    s_add_u32 s74, s74, s77
    s_add_u32 s74, s74, 0x100000
    s_getpc_b64 s[80:81]
    s_add_u32 s80, s80, Lret22-.+0
    s_addc_u32 s81, s81, 0
    s_branch L_chunk0
Lret22:
    s_mov_b32 s79, 0
    s_xor_b32 s74, s76, 65536
    s_add_u32 s74, s74, s77
    s_add_u32 s74, s74, 0x100000
    s_getpc_b64 s[80:81]
    s_add_u32 s80, s80, Lret23-.+0
    s_addc_u32 s81, s81, 0
    s_branch L_chunk
Lret23:
    s_setprio 2
    s_barrier
    s_lshl_b32 s70, s69, 11
    s_lshr_b32 s71, s68, 2
    s_xor_b32 s71, s71, 0
    s_lshl_b32 s71, s71, 19
    s_add_u32 m0, s70, 32768
    s_nop 0
    buffer_load_dwordx4 v164, s[24:27], s71 offen offset:0  lds
    buffer_load_dwordx4 v165, s[24:27], s71 offen offset:1024  lds
    s_add_u32 m0, s70, 40960
    s_add_u32 s71, s71, 131072
    buffer_load_dwordx4 v164, s[24:27], s71 offen offset:0  lds
    buffer_load_dwordx4 v165, s[24:27], s71 offen offset:1024  lds
    s_add_u32 m0, s70, 49152
    s_add_u32 s71, s71, 131072
    buffer_load_dwordx4 v164, s[24:27], s71 offen offset:0  lds
    buffer_load_dwordx4 v165, s[24:27], s71 offen offset:1024  lds
    s_add_u32 m0, s70, 57344
    s_add_u32 s71, s71, 131072
    buffer_load_dwordx4 v164, s[24:27], s71 offen offset:0  lds
    buffer_load_dwordx4 v165, s[24:27], s71 offen offset:1024  lds
    s_lshl_b32 s70, s69, 11
    s_lshr_b32 s71, s68, 2
    s_xor_b32 s71, s71, 2
    s_lshl_b32 s71, s71, 19
    s_add_u32 m0, s70, 98304
    s_nop 0
    buffer_load_dwordx4 v10, s[28:31], s71 offen offset:0  lds
    buffer_load_dwordx4 v11, s[28:31], s71 offen offset:1024  lds
    s_add_u32 m0, s70, 106496
    s_add_u32 s71, s71, 131072
    buffer_load_dwordx4 v10, s[28:31], s71 offen offset:0  lds
    buffer_load_dwordx4 v11, s[28:31], s71 offen offset:1024  lds
    s_add_u32 m0, s70, 114688
    s_add_u32 s71, s71, 131072
    buffer_load_dwordx4 v10, s[28:31], s71 offen offset:0  lds
    buffer_load_dwordx4 v11, s[28:31], s71 offen offset:1024  lds
    s_add_u32 m0, s70, 122880
    s_add_u32 s71, s71, 131072
    buffer_load_dwordx4 v10, s[28:31], s71 offen offset:0  lds
    buffer_load_dwordx4 v11, s[28:31], s71 offen offset:1024  lds
    s_lshl_b32 s70, s69, 11
    s_lshr_b32 s71, s68, 2
    s_xor_b32 s71, s71, 3
    s_lshl_b32 s71, s71, 19
    s_add_u32 m0, s70, 131072
    s_nop 0
    buffer_load_dwordx4 v10, s[28:31], s71 offen offset:0  lds
    buffer_load_dwordx4 v11, s[28:31], s71 offen offset:1024  lds
    s_add_u32 m0, s70, 139264
    s_add_u32 s71, s71, 131072
    buffer_load_dwordx4 v10, s[28:31], s71 offen offset:0  lds
    buffer_load_dwordx4 v11, s[28:31], s71 offen offset:1024  lds
    s_add_u32 m0, s70, 147456
    s_add_u32 s71, s71, 131072
    buffer_load_dwordx4 v10, s[28:31], s71 offen offset:0  lds
    buffer_load_dwordx4 v11, s[28:31], s71 offen offset:1024  lds
    s_add_u32 m0, s70, 155648
    s_add_u32 s71, s71, 131072
    buffer_load_dwordx4 v10, s[28:31], s71 offen offset:0  lds
    buffer_load_dwordx4 v11, s[28:31], s71 offen offset:1024  lds
    v_add_u32 v8, 0, v12
    v_xor_b32 v9, 32, v8
    v_xor_b32 v1, 64, v8
    v_xor_b32 v13, 96, v8
    ds_read_b64_tr_b16 v[16:17], v8 offset:0
    ds_read_b64_tr_b16 v[18:19], v8 offset:1024
    ds_read_b64_tr_b16 v[20:21], v9 offset:0
    ds_read_b64_tr_b16 v[22:23], v9 offset:1024
    ds_read_b64_tr_b16 v[24:25], v1 offset:0
    ds_read_b64_tr_b16 v[26:27], v1 offset:1024
    ds_read_b64_tr_b16 v[28:29], v13 offset:0
    ds_read_b64_tr_b16 v[30:31], v13 offset:1024
    s_waitcnt vmcnt(0)
    s_barrier
    s_mov_b32 s79, 32768
    s_xor_b32 s74, s76, 0
    s_add_u32 s74, s74, s77
    s_add_u32 s74, s74, 0x100000
    s_getpc_b64 s[80:81]
    s_add_u32 s80, s80, Lret24-.+0
    s_addc_u32 s81, s81, 0
    s_branch L_chunk
Lret24:
    s_barrier
    s_mov_b32 s79, 98304
    s_xor_b32 s74, s76, 131072
    s_add_u32 s74, s74, s77
    s_add_u32 s74, s74, 0x500000
    s_getpc_b64 s[80:81]
    s_add_u32 s80, s80, Lret25-.+0
    s_addc_u32 s81, s81, 0
    s_branch L_chunk
Lret25:
    s_nop 7
    v_cvt_pk_bf16_f32 v144, v112, v113
    v_cvt_pk_bf16_f32 v145, v114, v115
    v_cvt_pk_bf16_f32 v146, v116, v117
    v_cvt_pk_bf16_f32 v147, v118, v119
    v_cvt_pk_bf16_f32 v148, v120, v121
    v_cvt_pk_bf16_f32 v149, v122, v123
    v_cvt_pk_bf16_f32 v150, v124, v125
    v_cvt_pk_bf16_f32 v151, v126, v127
    v_cvt_pk_bf16_f32 v152, v128, v129
    v_cvt_pk_bf16_f32 v153, v130, v131
    v_cvt_pk_bf16_f32 v154, v132, v133
    v_cvt_pk_bf16_f32 v155, v134, v135
    v_cvt_pk_bf16_f32 v156, v136, v137
    v_cvt_pk_bf16_f32 v157, v138, v139
    v_cvt_pk_bf16_f32 v158, v140, v141
    v_cvt_pk_bf16_f32 v159, v142, v143
    s_waitcnt lgkmcnt(0)
    s_barrier
    ds_write_b64 v4, v[144:145] offset:0
    ds_write_b64 v5, v[146:147] offset:0
    ds_write_b64 v6, v[148:149] offset:0
    ds_write_b64 v7, v[150:151] offset:0
    ds_write_b64 v4, v[152:153] offset:2048
    ds_write_b64 v5, v[154:155] offset:2048
    ds_write_b64 v6, v[156:157] offset:2048
    ds_write_b64 v7, v[158:159] offset:2048
    s_waitcnt lgkmcnt(0)
    ds_read_b128 v[144:147], v14 offset:0
    ds_read_b128 v[148:151], v14 offset:1024
    ds_read_b128 v[152:155], v14 offset:2048
    ds_read_b128 v[156:159], v14 offset:3072
    s_lshl_b32 s70, s67, 7
    s_lshl_b32 s71, s69, 5
    s_add_u32 s70, s70, s71
    s_lshl_b32 s70, s70, 12
    s_lshl_b32 s71, s68, 7
    s_add_u32 s70, s70, s71
    s_add_u32 s70, s70, 0
    s_waitcnt lgkmcnt(3)
    buffer_store_dwordx4 v[144:147], v15, s[36:39], s70 offen sc1
    s_add_u32 s70, s70, 32768
    s_waitcnt lgkmcnt(2)
    buffer_store_dwordx4 v[148:151], v15, s[36:39], s70 offen sc1
    s_add_u32 s70, s70, 32768
    s_waitcnt lgkmcnt(1)
    buffer_store_dwordx4 v[152:155], v15, s[36:39], s70 offen sc1
    s_add_u32 s70, s70, 32768
    s_waitcnt lgkmcnt(0)
    buffer_store_dwordx4 v[156:159], v15, s[36:39], s70 offen sc1
    s_add_u32 s70, s70, 32768
    s_mov_b32 s79, 131072
    s_xor_b32 s74, s76, 196608
    s_add_u32 s74, s74, s77
    s_add_u32 s74, s74, 0x500000
    s_getpc_b64 s[80:81]
    s_add_u32 s80, s80, Lret26-.+0
    s_addc_u32 s81, s81, 0
    s_branch L_chunk0
Lret26:
    s_barrier
    s_mov_b32 s79, 65536
    s_xor_b32 s74, s76, 65536
    s_add_u32 s74, s74, s77
    s_add_u32 s74, s74, 0x500000
    s_getpc_b64 s[80:81]
    s_add_u32 s80, s80, Lret27-.+0
    s_addc_u32 s81, s81, 0
    s_branch L_chunk
Lret27:
    s_barrier
    s_mov_b32 s79, 0
    s_xor_b32 s74, s76, 0
    s_add_u32 s74, s74, s77
    s_add_u32 s74, s74, 0x500000
    s_getpc_b64 s[80:81]
    s_add_u32 s80, s80, Lret28-.+0
    s_addc_u32 s81, s81, 0
    s_branch L_chunk
Lret28:
    s_waitcnt vmcnt(15) lgkmcnt(4)
    v_mfma_f32_16x16x32_bf16 v[112:115], v[16:19], v[48:51], v[112:115]
    ds_read_b64_tr_b16 v[32:33], v8 offset:4096
    ds_read_b64_tr_b16 v[34:35], v8 offset:5120
    v_mfma_f32_16x16x32_bf16 v[116:119], v[20:23], v[48:51], v[116:119]
    ds_read_b64_tr_b16 v[36:37], v9 offset:4096
    ds_read_b64_tr_b16 v[38:39], v9 offset:5120
    s_waitcnt lgkmcnt(4)
    v_mfma_f32_16x16x32_bf16 v[120:123], v[24:27], v[48:51], v[120:123]
    ds_read_b64_tr_b16 v[40:41], v1 offset:4096
    v_mfma_f32_16x16x32_bf16 v[124:127], v[28:31], v[48:51], v[124:127]
    s_waitcnt vmcnt(14)
    v_mfma_f32_16x16x32_bf16 v[128:131], v[16:19], v[52:55], v[128:131]
    ds_read_b64_tr_b16 v[42:43], v1 offset:5120
    ds_read_b64_tr_b16 v[44:45], v13 offset:4096
    v_mfma_f32_16x16x32_bf16 v[132:135], v[20:23], v[52:55], v[132:135]
    ds_read_b64_tr_b16 v[46:47], v13 offset:5120
    v_mfma_f32_16x16x32_bf16 v[136:139], v[24:27], v[52:55], v[136:139]
    v_mfma_f32_16x16x32_bf16 v[140:143], v[28:31], v[52:55], v[140:143]
    s_waitcnt vmcnt(13) lgkmcnt(4)
    v_mfma_f32_16x16x32_bf16 v[112:115], v[32:35], v[56:59], v[112:115]
    ds_read_b64_tr_b16 v[16:17], v8 offset:8192
    ds_read_b64_tr_b16 v[18:19], v8 offset:9216
    v_mfma_f32_16x16x32_bf16 v[116:119], v[36:39], v[56:59], v[116:119]
    ds_read_b64_tr_b16 v[20:21], v9 offset:8192
    ds_read_b64_tr_b16 v[22:23], v9 offset:9216
    s_waitcnt lgkmcnt(4)
    v_mfma_f32_16x16x32_bf16 v[120:123], v[40:43], v[56:59], v[120:123]
    ds_read_b64_tr_b16 v[24:25], v1 offset:8192
    v_mfma_f32_16x16x32_bf16 v[124:127], v[44:47], v[56:59], v[124:127]
    s_waitcnt vmcnt(12)
    v_mfma_f32_16x16x32_bf16 v[128:131], v[32:35], v[60:63], v[128:131]
    ds_read_b64_tr_b16 v[26:27], v1 offset:9216
    ds_read_b64_tr_b16 v[28:29], v13 offset:8192
    v_mfma_f32_16x16x32_bf16 v[132:135], v[36:39], v[60:63], v[132:135]
    ds_read_b64_tr_b16 v[30:31], v13 offset:9216
    v_mfma_f32_16x16x32_bf16 v[136:139], v[40:43], v[60:63], v[136:139]
    v_mfma_f32_16x16x32_bf16 v[140:143], v[44:47], v[60:63], v[140:143]
    s_waitcnt vmcnt(11) lgkmcnt(4)
    v_mfma_f32_16x16x32_bf16 v[112:115], v[16:19], v[64:67], v[112:115]
    ds_read_b64_tr_b16 v[32:33], v8 offset:12288
    ds_read_b64_tr_b16 v[34:35], v8 offset:13312
    v_mfma_f32_16x16x32_bf16 v[116:119], v[20:23], v[64:67], v[116:119]
    ds_read_b64_tr_b16 v[36:37], v9 offset:12288
    ds_read_b64_tr_b16 v[38:39], v9 offset:13312
    s_waitcnt lgkmcnt(4)
    v_mfma_f32_16x16x32_bf16 v[120:123], v[24:27], v[64:67], v[120:123]
    ds_read_b64_tr_b16 v[40:41], v1 offset:12288
    v_mfma_f32_16x16x32_bf16 v[124:127], v[28:31], v[64:67], v[124:127]
    s_waitcnt vmcnt(10)
    v_mfma_f32_16x16x32_bf16 v[128:131], v[16:19], v[68:71], v[128:131]
    ds_read_b64_tr_b16 v[42:43], v1 offset:13312
    ds_read_b64_tr_b16 v[44:45], v13 offset:12288
    v_mfma_f32_16x16x32_bf16 v[132:135], v[20:23], v[68:71], v[132:135]
    ds_read_b64_tr_b16 v[46:47], v13 offset:13312
    v_mfma_f32_16x16x32_bf16 v[136:139], v[24:27], v[68:71], v[136:139]
    v_mfma_f32_16x16x32_bf16 v[140:143], v[28:31], v[68:71], v[140:143]
    s_waitcnt vmcnt(9) lgkmcnt(4)
    v_mfma_f32_16x16x32_bf16 v[112:115], v[32:35], v[72:75], v[112:115]
    ds_read_b64_tr_b16 v[16:17], v8 offset:16384
    ds_read_b64_tr_b16 v[18:19], v8 offset:17408
    v_mfma_f32_16x16x32_bf16 v[116:119], v[36:39], v[72:75], v[116:119]
    ds_read_b64_tr_b16 v[20:21], v9 offset:16384
    ds_read_b64_tr_b16 v[22:23], v9 offset:17408
    s_waitcnt lgkmcnt(4)
    v_mfma_f32_16x16x32_bf16 v[120:123], v[40:43], v[72:75], v[120:123]
    ds_read_b64_tr_b16 v[24:25], v1 offset:16384
    v_mfma_f32_16x16x32_bf16 v[124:127], v[44:47], v[72:75], v[124:127]
    s_waitcnt vmcnt(8)
    v_mfma_f32_16x16x32_bf16 v[128:131], v[32:35], v[76:79], v[128:131]
    ds_read_b64_tr_b16 v[26:27], v1 offset:17408
    ds_read_b64_tr_b16 v[28:29], v13 offset:16384
    v_mfma_f32_16x16x32_bf16 v[132:135], v[36:39], v[76:79], v[132:135]
    ds_read_b64_tr_b16 v[30:31], v13 offset:17408
    v_mfma_f32_16x16x32_bf16 v[136:139], v[40:43], v[76:79], v[136:139]
    v_mfma_f32_16x16x32_bf16 v[140:143], v[44:47], v[76:79], v[140:143]
    s_waitcnt vmcnt(7) lgkmcnt(4)
    v_mfma_f32_16x16x32_bf16 v[112:115], v[16:19], v[80:83], v[112:115]
    ds_read_b64_tr_b16 v[32:33], v8 offset:20480
    ds_read_b64_tr_b16 v[34:35], v8 offset:21504
    v_mfma_f32_16x16x32_bf16 v[116:119], v[20:23], v[80:83], v[116:119]
    ds_read_b64_tr_b16 v[36:37], v9 offset:20480
    ds_read_b64_tr_b16 v[38:39], v9 offset:21504
    s_waitcnt lgkmcnt(4)
    v_mfma_f32_16x16x32_bf16 v[120:123], v[24:27], v[80:83], v[120:123]
    ds_read_b64_tr_b16 v[40:41], v1 offset:20480
    v_mfma_f32_16x16x32_bf16 v[124:127], v[28:31], v[80:83], v[124:127]
    s_waitcnt vmcnt(6)
    v_mfma_f32_16x16x32_bf16 v[128:131], v[16:19], v[84:87], v[128:131]
    ds_read_b64_tr_b16 v[42:43], v1 offset:21504
    ds_read_b64_tr_b16 v[44:45], v13 offset:20480
    v_mfma_f32_16x16x32_bf16 v[132:135], v[20:23], v[84:87], v[132:135]
    ds_read_b64_tr_b16 v[46:47], v13 offset:21504
    v_mfma_f32_16x16x32_bf16 v[136:139], v[24:27], v[84:87], v[136:139]
    v_mfma_f32_16x16x32_bf16 v[140:143], v[28:31], v[84:87], v[140:143]
    s_waitcnt vmcnt(5) lgkmcnt(4)
    v_mfma_f32_16x16x32_bf16 v[112:115], v[32:35], v[88:91], v[112:115]
    ds_read_b64_tr_b16 v[16:17], v8 offset:24576
    ds_read_b64_tr_b16 v[18:19], v8 offset:25600
    v_mfma_f32_16x16x32_bf16 v[116:119], v[36:39], v[88:91], v[116:119]
    ds_read_b64_tr_b16 v[20:21], v9 offset:24576
    ds_read_b64_tr_b16 v[22:23], v9 offset:25600
    s_waitcnt lgkmcnt(4)
    v_mfma_f32_16x16x32_bf16 v[120:123], v[40:43], v[88:91], v[120:123]
    ds_read_b64_tr_b16 v[24:25], v1 offset:24576
    v_mfma_f32_16x16x32_bf16 v[124:127], v[44:47], v[88:91], v[124:127]
    s_waitcnt vmcnt(4)
    v_mfma_f32_16x16x32_bf16 v[128:131], v[32:35], v[92:95], v[128:131]
    ds_read_b64_tr_b16 v[26:27], v1 offset:25600
    ds_read_b64_tr_b16 v[28:29], v13 offset:24576
    v_mfma_f32_16x16x32_bf16 v[132:135], v[36:39], v[92:95], v[132:135]
    ds_read_b64_tr_b16 v[30:31], v13 offset:25600
    v_mfma_f32_16x16x32_bf16 v[136:139], v[40:43], v[92:95], v[136:139]
    v_mfma_f32_16x16x32_bf16 v[140:143], v[44:47], v[92:95], v[140:143]
    s_waitcnt vmcnt(3) lgkmcnt(4)
    v_mfma_f32_16x16x32_bf16 v[112:115], v[16:19], v[96:99], v[112:115]
    ds_read_b64_tr_b16 v[32:33], v8 offset:28672
    ds_read_b64_tr_b16 v[34:35], v8 offset:29696
    v_mfma_f32_16x16x32_bf16 v[116:119], v[20:23], v[96:99], v[116:119]
    ds_read_b64_tr_b16 v[36:37], v9 offset:28672
    ds_read_b64_tr_b16 v[38:39], v9 offset:29696
    s_waitcnt lgkmcnt(4)
    v_mfma_f32_16x16x32_bf16 v[120:123], v[24:27], v[96:99], v[120:123]
    ds_read_b64_tr_b16 v[40:41], v1 offset:28672
    v_mfma_f32_16x16x32_bf16 v[124:127], v[28:31], v[96:99], v[124:127]
    s_waitcnt vmcnt(2)
    v_mfma_f32_16x16x32_bf16 v[128:131], v[16:19], v[100:103], v[128:131]
    ds_read_b64_tr_b16 v[42:43], v1 offset:29696
    ds_read_b64_tr_b16 v[44:45], v13 offset:28672
    v_mfma_f32_16x16x32_bf16 v[132:135], v[20:23], v[100:103], v[132:135]
    ds_read_b64_tr_b16 v[46:47], v13 offset:29696
    v_mfma_f32_16x16x32_bf16 v[136:139], v[24:27], v[100:103], v[136:139]
    v_mfma_f32_16x16x32_bf16 v[140:143], v[28:31], v[100:103], v[140:143]
    s_waitcnt vmcnt(1) lgkmcnt(4)
    v_mfma_f32_16x16x32_bf16 v[112:115], v[32:35], v[104:107], v[112:115]
    v_mfma_f32_16x16x32_bf16 v[116:119], v[36:39], v[104:107], v[116:119]
    s_waitcnt lgkmcnt(0)
    v_mfma_f32_16x16x32_bf16 v[120:123], v[40:43], v[104:107], v[120:123]
    v_mfma_f32_16x16x32_bf16 v[124:127], v[44:47], v[104:107], v[124:127]
    s_waitcnt vmcnt(0)
    v_mfma_f32_16x16x32_bf16 v[128:131], v[32:35], v[108:111], v[128:131]
    v_mfma_f32_16x16x32_bf16 v[132:135], v[36:39], v[108:111], v[132:135]
    v_mfma_f32_16x16x32_bf16 v[136:139], v[40:43], v[108:111], v[136:139]
    v_mfma_f32_16x16x32_bf16 v[140:143], v[44:47], v[108:111], v[140:143]
    s_nop 7
    v_cvt_pk_bf16_f32 v144, v112, v113
    v_cvt_pk_bf16_f32 v145, v114, v115
    v_cvt_pk_bf16_f32 v146, v116, v117
    v_cvt_pk_bf16_f32 v147, v118, v119
    v_cvt_pk_bf16_f32 v148, v120, v121
    v_cvt_pk_bf16_f32 v149, v122, v123
    v_cvt_pk_bf16_f32 v150, v124, v125
    v_cvt_pk_bf16_f32 v151, v126, v127
    v_cvt_pk_bf16_f32 v152, v128, v129
    v_cvt_pk_bf16_f32 v153, v130, v131
    v_cvt_pk_bf16_f32 v154, v132, v133
    v_cvt_pk_bf16_f32 v155, v134, v135
    v_cvt_pk_bf16_f32 v156, v136, v137
    v_cvt_pk_bf16_f32 v157, v138, v139
    v_cvt_pk_bf16_f32 v158, v140, v141
    v_cvt_pk_bf16_f32 v159, v142, v143
    s_waitcnt lgkmcnt(0)
    ds_write_b64 v4, v[144:145] offset:0
    ds_write_b64 v5, v[146:147] offset:0
    ds_write_b64 v6, v[148:149] offset:0
    ds_write_b64 v7, v[150:151] offset:0
    ds_write_b64 v4, v[152:153] offset:2048
    ds_write_b64 v5, v[154:155] offset:2048
    ds_write_b64 v6, v[156:157] offset:2048
    ds_write_b64 v7, v[158:159] offset:2048
    s_waitcnt lgkmcnt(0)
    ds_read_b128 v[144:147], v14 offset:0
    ds_read_b128 v[148:151], v14 offset:1024
    ds_read_b128 v[152:155], v14 offset:2048
    ds_read_b128 v[156:159], v14 offset:3072
    s_lshl_b32 s70, s67, 7
    s_lshl_b32 s71, s69, 5
    s_add_u32 s70, s70, s71
    s_lshl_b32 s70, s70, 12
    s_lshl_b32 s71, s68, 7
    s_add_u32 s70, s70, s71
    s_add_u32 s70, s70, 2048
    s_waitcnt lgkmcnt(3)
    buffer_store_dwordx4 v[144:147], v15, s[36:39], s70 offen sc1
    s_add_u32 s70, s70, 32768
    s_waitcnt lgkmcnt(2)
    buffer_store_dwordx4 v[148:151], v15, s[36:39], s70 offen sc1
    s_add_u32 s70, s70, 32768
    s_waitcnt lgkmcnt(1)
    buffer_store_dwordx4 v[152:155], v15, s[36:39], s70 offen sc1
    s_add_u32 s70, s70, 32768
    s_waitcnt lgkmcnt(0)
    buffer_store_dwordx4 v[156:159], v15, s[36:39], s70 offen sc1
    s_add_u32 s70, s70, 32768
    s_endpgm
L_chunk0:
    s_waitcnt vmcnt(15) lgkmcnt(4)
    v_mfma_f32_16x16x32_bf16 v[112:115], v[16:19], v[48:51], 0
    ds_read_b64_tr_b16 v[32:33], v8 offset:4096
    ds_read_b64_tr_b16 v[34:35], v8 offset:5120
    v_mfma_f32_16x16x32_bf16 v[116:119], v[20:23], v[48:51], 0
    ds_read_b64_tr_b16 v[36:37], v9 offset:4096
    ds_read_b64_tr_b16 v[38:39], v9 offset:5120
    s_waitcnt lgkmcnt(4)
    v_mfma_f32_16x16x32_bf16 v[120:123], v[24:27], v[48:51], 0
    ds_read_b64_tr_b16 v[40:41], v1 offset:4096
    s_add_u32 s75, s74, 0
    v_mfma_f32_16x16x32_bf16 v[124:127], v[28:31], v[48:51], 0
    buffer_load_dwordx4 v[48:51], v3, s[20:23], s75 offen offset:0 sc1
    s_waitcnt vmcnt(15)
    v_mfma_f32_16x16x32_bf16 v[128:131], v[16:19], v[52:55], 0
    ds_read_b64_tr_b16 v[42:43], v1 offset:5120
    ds_read_b64_tr_b16 v[44:45], v13 offset:4096
    v_mfma_f32_16x16x32_bf16 v[132:135], v[20:23], v[52:55], 0
    ds_read_b64_tr_b16 v[46:47], v13 offset:5120
    v_mfma_f32_16x16x32_bf16 v[136:139], v[24:27], v[52:55], 0
    v_mfma_f32_16x16x32_bf16 v[140:143], v[28:31], v[52:55], 0
    buffer_load_dwordx4 v[52:55], v3, s[20:23], s75 offen offset:256 sc1
    s_branch L_chunk_p1
.p2align 6
L_chunk:
    s_waitcnt vmcnt(15) lgkmcnt(4)
    v_mfma_f32_16x16x32_bf16 v[112:115], v[16:19], v[48:51], v[112:115]
    ds_read_b64_tr_b16 v[32:33], v8 offset:4096
    ds_read_b64_tr_b16 v[34:35], v8 offset:5120
    v_mfma_f32_16x16x32_bf16 v[116:119], v[20:23], v[48:51], v[116:119]
    ds_read_b64_tr_b16 v[36:37], v9 offset:4096
    ds_read_b64_tr_b16 v[38:39], v9 offset:5120
    s_waitcnt lgkmcnt(4)
    v_mfma_f32_16x16x32_bf16 v[120:123], v[24:27], v[48:51], v[120:123]
    ds_read_b64_tr_b16 v[40:41], v1 offset:4096
    s_add_u32 s75, s74, 0
    v_mfma_f32_16x16x32_bf16 v[124:127], v[28:31], v[48:51], v[124:127]
    buffer_load_dwordx4 v[48:51], v3, s[20:23], s75 offen offset:0 sc1
    s_waitcnt vmcnt(15)
    v_mfma_f32_16x16x32_bf16 v[128:131], v[16:19], v[52:55], v[128:131]
    ds_read_b64_tr_b16 v[42:43], v1 offset:5120
    ds_read_b64_tr_b16 v[44:45], v13 offset:4096
    v_mfma_f32_16x16x32_bf16 v[132:135], v[20:23], v[52:55], v[132:135]
    ds_read_b64_tr_b16 v[46:47], v13 offset:5120
    v_mfma_f32_16x16x32_bf16 v[136:139], v[24:27], v[52:55], v[136:139]
    v_mfma_f32_16x16x32_bf16 v[140:143], v[28:31], v[52:55], v[140:143]
    buffer_load_dwordx4 v[52:55], v3, s[20:23], s75 offen offset:256 sc1
L_chunk_p1:
    s_waitcnt vmcnt(15) lgkmcnt(4)
    v_mfma_f32_16x16x32_bf16 v[112:115], v[32:35], v[56:59], v[112:115]
    ds_read_b64_tr_b16 v[16:17], v8 offset:8192
    ds_read_b64_tr_b16 v[18:19], v8 offset:9216
    v_mfma_f32_16x16x32_bf16 v[116:119], v[36:39], v[56:59], v[116:119]
    ds_read_b64_tr_b16 v[20:21], v9 offset:8192
    ds_read_b64_tr_b16 v[22:23], v9 offset:9216
    s_waitcnt lgkmcnt(4)
    v_mfma_f32_16x16x32_bf16 v[120:123], v[40:43], v[56:59], v[120:123]
    ds_read_b64_tr_b16 v[24:25], v1 offset:8192
    s_add_u32 s75, s74, 8192
    v_mfma_f32_16x16x32_bf16 v[124:127], v[44:47], v[56:59], v[124:127]
    buffer_load_dwordx4 v[56:59], v3, s[20:23], s75 offen offset:0 sc1
    s_waitcnt vmcnt(15)
    v_mfma_f32_16x16x32_bf16 v[128:131], v[32:35], v[60:63], v[128:131]
    ds_read_b64_tr_b16 v[26:27], v1 offset:9216
    ds_read_b64_tr_b16 v[28:29], v13 offset:8192
    v_mfma_f32_16x16x32_bf16 v[132:135], v[36:39], v[60:63], v[132:135]
    ds_read_b64_tr_b16 v[30:31], v13 offset:9216
    v_mfma_f32_16x16x32_bf16 v[136:139], v[40:43], v[60:63], v[136:139]
    v_mfma_f32_16x16x32_bf16 v[140:143], v[44:47], v[60:63], v[140:143]
    buffer_load_dwordx4 v[60:63], v3, s[20:23], s75 offen offset:256 sc1
    s_waitcnt vmcnt(15) lgkmcnt(4)
    v_mfma_f32_16x16x32_bf16 v[112:115], v[16:19], v[64:67], v[112:115]
    ds_read_b64_tr_b16 v[32:33], v8 offset:12288
    ds_read_b64_tr_b16 v[34:35], v8 offset:13312
    v_mfma_f32_16x16x32_bf16 v[116:119], v[20:23], v[64:67], v[116:119]
    ds_read_b64_tr_b16 v[36:37], v9 offset:12288
    ds_read_b64_tr_b16 v[38:39], v9 offset:13312
    s_waitcnt lgkmcnt(4)
    v_mfma_f32_16x16x32_bf16 v[120:123], v[24:27], v[64:67], v[120:123]
    ds_read_b64_tr_b16 v[40:41], v1 offset:12288
    s_add_u32 s75, s74, 16384
    v_mfma_f32_16x16x32_bf16 v[124:127], v[28:31], v[64:67], v[124:127]
    buffer_load_dwordx4 v[64:67], v3, s[20:23], s75 offen offset:0 sc1
    s_waitcnt vmcnt(15)
    v_mfma_f32_16x16x32_bf16 v[128:131], v[16:19], v[68:71], v[128:131]
    ds_read_b64_tr_b16 v[42:43], v1 offset:13312
    ds_read_b64_tr_b16 v[44:45], v13 offset:12288
    v_mfma_f32_16x16x32_bf16 v[132:135], v[20:23], v[68:71], v[132:135]
    ds_read_b64_tr_b16 v[46:47], v13 offset:13312
    v_mfma_f32_16x16x32_bf16 v[136:139], v[24:27], v[68:71], v[136:139]
    v_mfma_f32_16x16x32_bf16 v[140:143], v[28:31], v[68:71], v[140:143]
    buffer_load_dwordx4 v[68:71], v3, s[20:23], s75 offen offset:256 sc1
    s_waitcnt vmcnt(15) lgkmcnt(4)
    v_mfma_f32_16x16x32_bf16 v[112:115], v[32:35], v[72:75], v[112:115]
    ds_read_b64_tr_b16 v[16:17], v8 offset:16384
    ds_read_b64_tr_b16 v[18:19], v8 offset:17408
    v_mfma_f32_16x16x32_bf16 v[116:119], v[36:39], v[72:75], v[116:119]
    ds_read_b64_tr_b16 v[20:21], v9 offset:16384
    ds_read_b64_tr_b16 v[22:23], v9 offset:17408
    s_waitcnt lgkmcnt(4)
    v_mfma_f32_16x16x32_bf16 v[120:123], v[40:43], v[72:75], v[120:123]
    ds_read_b64_tr_b16 v[24:25], v1 offset:16384
    s_add_u32 s75, s74, 24576
    v_mfma_f32_16x16x32_bf16 v[124:127], v[44:47], v[72:75], v[124:127]
    buffer_load_dwordx4 v[72:75], v3, s[20:23], s75 offen offset:0 sc1
    s_waitcnt vmcnt(15)
    v_mfma_f32_16x16x32_bf16 v[128:131], v[32:35], v[76:79], v[128:131]
    ds_read_b64_tr_b16 v[26:27], v1 offset:17408
    ds_read_b64_tr_b16 v[28:29], v13 offset:16384
    v_mfma_f32_16x16x32_bf16 v[132:135], v[36:39], v[76:79], v[132:135]
    ds_read_b64_tr_b16 v[30:31], v13 offset:17408
    v_mfma_f32_16x16x32_bf16 v[136:139], v[40:43], v[76:79], v[136:139]
    v_mfma_f32_16x16x32_bf16 v[140:143], v[44:47], v[76:79], v[140:143]
    buffer_load_dwordx4 v[76:79], v3, s[20:23], s75 offen offset:256 sc1
    s_waitcnt vmcnt(15) lgkmcnt(4)
    v_mfma_f32_16x16x32_bf16 v[112:115], v[16:19], v[80:83], v[112:115]
    ds_read_b64_tr_b16 v[32:33], v8 offset:20480
    ds_read_b64_tr_b16 v[34:35], v8 offset:21504
    v_mfma_f32_16x16x32_bf16 v[116:119], v[20:23], v[80:83], v[116:119]
    ds_read_b64_tr_b16 v[36:37], v9 offset:20480
    ds_read_b64_tr_b16 v[38:39], v9 offset:21504
    s_waitcnt lgkmcnt(4)
    v_mfma_f32_16x16x32_bf16 v[120:123], v[24:27], v[80:83], v[120:123]
    ds_read_b64_tr_b16 v[40:41], v1 offset:20480
    s_add_u32 s75, s74, 32768
    v_mfma_f32_16x16x32_bf16 v[124:127], v[28:31], v[80:83], v[124:127]
    buffer_load_dwordx4 v[80:83], v3, s[20:23], s75 offen offset:0 sc1
    s_waitcnt vmcnt(15)
    v_mfma_f32_16x16x32_bf16 v[128:131], v[16:19], v[84:87], v[128:131]
    ds_read_b64_tr_b16 v[42:43], v1 offset:21504
    ds_read_b64_tr_b16 v[44:45], v13 offset:20480
    v_mfma_f32_16x16x32_bf16 v[132:135], v[20:23], v[84:87], v[132:135]
    ds_read_b64_tr_b16 v[46:47], v13 offset:21504
    v_mfma_f32_16x16x32_bf16 v[136:139], v[24:27], v[84:87], v[136:139]
    v_mfma_f32_16x16x32_bf16 v[140:143], v[28:31], v[84:87], v[140:143]
    buffer_load_dwordx4 v[84:87], v3, s[20:23], s75 offen offset:256 sc1
    s_waitcnt vmcnt(15) lgkmcnt(4)
    v_mfma_f32_16x16x32_bf16 v[112:115], v[32:35], v[88:91], v[112:115]
    ds_read_b64_tr_b16 v[16:17], v8 offset:24576
    ds_read_b64_tr_b16 v[18:19], v8 offset:25600
    v_mfma_f32_16x16x32_bf16 v[116:119], v[36:39], v[88:91], v[116:119]
    ds_read_b64_tr_b16 v[20:21], v9 offset:24576
    ds_read_b64_tr_b16 v[22:23], v9 offset:25600
    s_waitcnt lgkmcnt(4)
    v_mfma_f32_16x16x32_bf16 v[120:123], v[40:43], v[88:91], v[120:123]
    ds_read_b64_tr_b16 v[24:25], v1 offset:24576
    s_add_u32 s75, s74, 40960
    v_mfma_f32_16x16x32_bf16 v[124:127], v[44:47], v[88:91], v[124:127]
    buffer_load_dwordx4 v[88:91], v3, s[20:23], s75 offen offset:0 sc1
    s_waitcnt vmcnt(15)
    v_mfma_f32_16x16x32_bf16 v[128:131], v[32:35], v[92:95], v[128:131]
    ds_read_b64_tr_b16 v[26:27], v1 offset:25600
    ds_read_b64_tr_b16 v[28:29], v13 offset:24576
    v_mfma_f32_16x16x32_bf16 v[132:135], v[36:39], v[92:95], v[132:135]
    ds_read_b64_tr_b16 v[30:31], v13 offset:25600
    v_mfma_f32_16x16x32_bf16 v[136:139], v[40:43], v[92:95], v[136:139]
    v_mfma_f32_16x16x32_bf16 v[140:143], v[44:47], v[92:95], v[140:143]
    buffer_load_dwordx4 v[92:95], v3, s[20:23], s75 offen offset:256 sc1
    s_waitcnt vmcnt(15) lgkmcnt(4)
    v_mfma_f32_16x16x32_bf16 v[112:115], v[16:19], v[96:99], v[112:115]
    ds_read_b64_tr_b16 v[32:33], v8 offset:28672
    ds_read_b64_tr_b16 v[34:35], v8 offset:29696
    v_mfma_f32_16x16x32_bf16 v[116:119], v[20:23], v[96:99], v[116:119]
    ds_read_b64_tr_b16 v[36:37], v9 offset:28672
    ds_read_b64_tr_b16 v[38:39], v9 offset:29696
    s_waitcnt lgkmcnt(4)
    v_mfma_f32_16x16x32_bf16 v[120:123], v[24:27], v[96:99], v[120:123]
    ds_read_b64_tr_b16 v[40:41], v1 offset:28672
    s_add_u32 s75, s74, 49152
    v_mfma_f32_16x16x32_bf16 v[124:127], v[28:31], v[96:99], v[124:127]
    buffer_load_dwordx4 v[96:99], v3, s[20:23], s75 offen offset:0 sc1
    s_waitcnt vmcnt(15)
    v_mfma_f32_16x16x32_bf16 v[128:131], v[16:19], v[100:103], v[128:131]
    ds_read_b64_tr_b16 v[42:43], v1 offset:29696
    ds_read_b64_tr_b16 v[44:45], v13 offset:28672
    v_mfma_f32_16x16x32_bf16 v[132:135], v[20:23], v[100:103], v[132:135]
    ds_read_b64_tr_b16 v[46:47], v13 offset:29696
    v_add_u32 v8, s79, v12
    v_mfma_f32_16x16x32_bf16 v[136:139], v[24:27], v[100:103], v[136:139]
    v_xor_b32 v9, 32, v8
    v_xor_b32 v1, 64, v8
    v_mfma_f32_16x16x32_bf16 v[140:143], v[28:31], v[100:103], v[140:143]
    v_xor_b32 v13, 96, v8
    buffer_load_dwordx4 v[100:103], v3, s[20:23], s75 offen offset:256 sc1
    s_waitcnt vmcnt(15) lgkmcnt(4)
    v_mfma_f32_16x16x32_bf16 v[112:115], v[32:35], v[104:107], v[112:115]
    ds_read_b64_tr_b16 v[16:17], v8 offset:0
    ds_read_b64_tr_b16 v[18:19], v8 offset:1024
    v_mfma_f32_16x16x32_bf16 v[116:119], v[36:39], v[104:107], v[116:119]
    ds_read_b64_tr_b16 v[20:21], v9 offset:0
    ds_read_b64_tr_b16 v[22:23], v9 offset:1024
    s_waitcnt lgkmcnt(4)
    v_mfma_f32_16x16x32_bf16 v[120:123], v[40:43], v[104:107], v[120:123]
    ds_read_b64_tr_b16 v[24:25], v1 offset:0
    s_add_u32 s75, s74, 57344
    v_mfma_f32_16x16x32_bf16 v[124:127], v[44:47], v[104:107], v[124:127]
    buffer_load_dwordx4 v[104:107], v3, s[20:23], s75 offen offset:0 sc1
    s_waitcnt vmcnt(15)
    v_mfma_f32_16x16x32_bf16 v[128:131], v[32:35], v[108:111], v[128:131]
    ds_read_b64_tr_b16 v[26:27], v1 offset:1024
    ds_read_b64_tr_b16 v[28:29], v13 offset:0
    v_mfma_f32_16x16x32_bf16 v[132:135], v[36:39], v[108:111], v[132:135]
    ds_read_b64_tr_b16 v[30:31], v13 offset:1024
    v_mfma_f32_16x16x32_bf16 v[136:139], v[40:43], v[108:111], v[136:139]
    v_mfma_f32_16x16x32_bf16 v[140:143], v[44:47], v[108:111], v[140:143]
    buffer_load_dwordx4 v[108:111], v3, s[20:23], s75 offen offset:256 sc1
    s_setpc_b64 s[80:81]
L_end:
    s_endpgm
.section .rodata,"a"
.p2align 6
.amdhsa_kernel concat_heads__linear_attn_block__grouped_kv_mqa__prompt_kernel
  .amdhsa_next_free_vgpr 168
  .amdhsa_next_free_sgpr 84
  .amdhsa_accum_offset 168
  .amdhsa_group_segment_fixed_size 0
  .amdhsa_kernarg_size 88
  .amdhsa_user_sgpr_count 2
  .amdhsa_user_sgpr_kernarg_segment_ptr 1
  .amdhsa_system_sgpr_workgroup_id_x 1
.end_amdhsa_kernel
```
